```python
import torch

def _softmax(x, axis=-1):
    return torch.softmax(x, dim=axis)

def _gelu(x):
    return torch.nn.functional.gelu(x, approximate='tanh')

def _silu(x):
    return torch.nn.functional.silu(x)

def _sigmoid(x):
    return torch.sigmoid(x)

def _layernorm(x, axis=-1, eps=1e-05):
    m = x.mean(dim=axis, keepdim=True)
    v = x.var(dim=axis, keepdim=True, unbiased=False)
    return (x - m) / torch.sqrt(v + eps)

def _scatter_add(tgt, idx, src, axis=0):
    return tgt.clone().index_add_(axis, idx, src)

def _segment_sum(src, seg, n):
    out = torch.zeros((n,) + src.shape[1:], dtype=src.dtype)
    return out.index_add_(0, seg, src)

def _pad(x, pw):
    flat = tuple((v for pair in reversed(pw) for v in pair))
    return torch.nn.functional.pad(x, flat)
kernel_name = 'concat_heads__linear_kernel_hedgehog__memory_aug_recurrent_mem_tr__prompt'

def setup_inputs():

    _w = lambda a: (lambda t: t.to(torch.bfloat16) if t.is_floating_point() else t)(torch.as_tensor(a))

    def _A_setup():
        B, S, D, H = (1, 2048, 512, 32)
        Dh = D // H
        return {'x': _w((lambda *s: torch.randn(*s, dtype=torch.bfloat16) * 0.8)(B, S, D)), 'wqkv': _w((lambda *s: torch.randn(*s, dtype=torch.bfloat16) * 0.8)(D, 3 * D)), 'w_phi': _w((lambda *s: torch.randn(*s, dtype=torch.bfloat16) * 0.8)(H, Dh, Dh) * Dh ** (-0.5)), 'wo': _w((lambda *s: torch.randn(*s, dtype=torch.bfloat16) * 0.05)(D, D))}
    _A_in = _A_setup()

    def _B_setup():
        B, S, Dm = (1, 2048, 512)
        H, Dh = (32, 128)
        M, seg = (8, 32)
        seg = min(seg, S)
        S = S // seg * seg
        return {'x': _w((lambda *s: torch.randn(*s, dtype=torch.bfloat16) * 0.05)(B, S, Dm)), 'mem0': _w((lambda *s: torch.randn(*s, dtype=torch.bfloat16) * 1.6)(B, M, Dm)), 'Wq': _w((lambda *s: torch.randn(*s, dtype=torch.bfloat16) * 0.8)(Dm, H, Dh) * Dm ** (-0.5)), 'Wk': _w((lambda *s: torch.randn(*s, dtype=torch.bfloat16) * 0.8)(Dm, H, Dh) * Dm ** (-0.5)), 'Wv': _w((lambda *s: torch.randn(*s, dtype=torch.bfloat16) * 1.6)(Dm, H, Dh) * Dm ** (-0.5)), 'Wo': _w((lambda *s: torch.randn(*s, dtype=torch.bfloat16) * 1.6)(H, Dh, Dm) * (H * Dh) ** (-0.5)), 'seg_len': seg}
    _B_in = _B_setup()
    return {'A_x': _A_in['x'], 'A_wqkv': _A_in['wqkv'], 'A_w_phi': _A_in['w_phi'], 'A_wo': _A_in['wo'], 'B_x': _B_in['x'], 'B_mem0': _B_in['mem0'], 'B_Wq': _B_in['Wq'], 'B_Wk': _B_in['Wk'], 'B_Wv': _B_in['Wv'], 'B_Wo': _B_in['Wo'], 'B_seg_len': _B_in['seg_len']}

def reference(A_x, A_wqkv, A_w_phi, A_wo, B_x, B_mem0, B_Wq, B_Wk, B_Wv, B_Wo, B_seg_len):

    def _A_ref(x, wqkv, w_phi, wo):
        B, S, D = x.shape
        H = 32
        Dh = D // H
        qkv = (lambda x, *d: x.permute(*d))((x @ wqkv).reshape(B, S, 3, H, Dh), 2, 0, 3, 1, 4)
        q, k, v = (qkv[0], qkv[1], qkv[2])
        pq = torch.einsum('bhsd,hdf->bhsf', q, w_phi)
        pk = torch.einsum('bhsd,hdf->bhsf', k, w_phi)
        phi_q = torch.concatenate([_softmax(pq, axis=-1), _softmax(-pq, axis=-1)], axis=-1)
        phi_k = torch.concatenate([_softmax(pk, axis=-1), _softmax(-pk, axis=-1)], axis=-1)
        kv = torch.einsum('bhsf,bhsd->bhfd', phi_k, v)
        z = torch.einsum('bhsf->bhf', phi_k)
        num = torch.einsum('bhqf,bhfd->bhqd', phi_q, kv)
        den = torch.einsum('bhqf,bhf->bhq', phi_q, z)[..., None] + 1e-06
        o = num / den
        return (lambda x, *d: x.permute(*d))(o, 0, 2, 1, 3).reshape(B, S, D) @ wo

    def _B_ref(x, mem0, Wq, Wk, Wv, Wo, seg_len):
        B, S, Dm = x.shape
        H, Dh = (Wq.shape[1], Wq.shape[2])
        M = mem0.shape[1]
        scale = Dh ** (-0.5)
        n_seg = S // seg_len
        L = M + seg_len
        idx = torch.arange(L)
        mask = (idx[:, None] < M) | (idx[:, None] >= idx[None, :])
        mem = mem0
        outs = []
        for s in range(n_seg):
            xs = x[:, s * seg_len:(s + 1) * seg_len, :].clone()
            h = torch.concatenate([mem, xs], axis=1)
            q = torch.einsum('btd,dhe->bhte', h, Wq)
            k = torch.einsum('btd,dhe->bhte', h, Wk)
            v = torch.einsum('btd,dhe->bhte', h, Wv)
            scores = torch.einsum('bhqe,bhke->bhqk', q, k) * scale
            scores = torch.where(mask[None, None], scores, -1000000000.0)
            p = _softmax(scores, axis=-1)
            o = torch.einsum('bhqk,bhke->bhqe', p, v)
            o = torch.einsum('bhte,hed->btd', o, Wo)
            mem = o[:, :M, :].clone()
            outs.append(o[:, M:, :])
        return torch.concatenate(outs, axis=1)
    a = _A_ref(A_x, A_wqkv, A_w_phi, A_wo)
    b = _B_ref(B_x, B_mem0, B_Wq, B_Wk, B_Wv, B_Wo, B_seg_len)
    return torch.concatenate([a, b], axis=-1)
```

```asm
; @launch grid=(256,1,1) block=(256,1,1) lds=163840
.amdgcn_target "amdgcn-amd-amdhsa--gfx950"
.text
.globl concat_heads__linear_kernel_hedgehog__memory_aug_recurrent_mem_tr__prompt_kernel
.p2align 8
.type concat_heads__linear_kernel_hedgehog__memory_aug_recurrent_mem_tr__prompt_kernel,@function
concat_heads__linear_kernel_hedgehog__memory_aug_recurrent_mem_tr__prompt_kernel:
    s_cmp_ge_u32 s2, 256
    s_cbranch_scc1 L_END
    s_load_dwordx16 s[8:23], s[0:1], 0
    s_load_dwordx8 s[24:31], s[0:1], 64
    s_load_dwordx4 s[32:35], s[0:1], 96
    s_getreg_b32 s62, hwreg(HW_REG_XCC_ID, 0, 3)
    s_add_u32 s62, s62, 5
    s_and_b32 s62, s62, 7
    s_and_b32 s63, s2, 0xf8
    s_or_b32 s62, s62, s63
    s_mov_b32 s96, 0
    s_mov_b32 s61, 300000
    v_lshrrev_b32 v1, 6, v0
    v_and_b32 v0, 63, v0
    v_readfirstlane_b32 s56, v1
    s_getpc_b64 s[4:5]
    s_lshr_b32 s63, s2, 3
    s_and_b32 s63, s63, 15
    s_lshl_b32 s63, s63, 12
    v_lshl_add_u32 v2, v0, 6, s63
    v_min_u32 v2, 0x9f90, v2
    s_cmp_lg_u32 s56, 0
    s_cbranch_scc1 L_NOPF
    global_load_dword v255, v2, s[4:5]
L_NOPF:
    s_waitcnt lgkmcnt(0)
    s_sub_u32 s97, 0, s34
    s_and_b32 s97, s97, 2097151
    s_add_u32 s97, s97, 65011712
    s_mov_b32 s36, s34
    s_and_b32 s37, s35, 0xffff
    s_mov_b32 s38, 75497472
    s_mov_b32 s39, 0x20000
    s_mov_b32 s40, s32
    s_and_b32 s41, s33, 0xffff
    s_mov_b32 s42, 256
    s_mov_b32 s43, 0x20000
L_START:
    s_and_b32 s63, s62, 7
    s_cmp_lg_u32 s63, 0
    s_cbranch_scc1 L_WORKER
    s_lshr_b32 s57, s62, 3
    s_mul_i32 s67, s56, 36864
    s_lshl_b32 s63, s56, 1
    s_and_b32 s64, s57, 7
    s_xor_b32 s68, s63, s64
    v_mov_b32 v24, v0
    v_bfe_u32 v28, v24, 3, 2
    v_bfe_u32 v34, v24, 5, 1
    v_lshl_add_u32 v28, v34, 3, v28
    v_lshlrev_b32 v28, 13, v28
    v_and_b32 v36, 7, v24
    v_lshl_add_u32 v28, v36, 4, v28
    v_lshrrev_b32 v36, 4, v24
    v_lshlrev_b32 v36, 5, v36
    v_xor_b32 v28, v36, v28
    v_mov_b32 v41, v28
    s_lshl_b32 s63, s57, 8
    s_lshr_b32 s64, s56, 1
    s_lshl_b32 s64, s64, 7
    s_add_u32 s83, s63, s64
    s_mov_b32 s44, s20
    s_and_b32 s45, s21, 0xffff
    s_mov_b32 s46, 4194304
    s_mov_b32 s47, 0x20000
    s_mov_b32 s44, s22
    s_and_b32 s45, s23, 0xffff
    s_xor_b32 s58, s68, 0
    s_lshl_b32 s58, s58, 19
    s_add_u32 s58, s58, s83
    s_add_u32 m0, s67, 0
    s_add_u32 s63, s58, 0
    buffer_load_dwordx4 v28, s[44:47], s63 offen  lds
    s_add_u32 m0, s67, 1024
    s_add_u32 s63, s58, 131072
    buffer_load_dwordx4 v41, s[44:47], s63 offen  lds
    s_add_u32 m0, s67, 2048
    s_add_u32 s63, s58, 32768
    buffer_load_dwordx4 v28, s[44:47], s63 offen  lds
    s_add_u32 m0, s67, 3072
    s_add_u32 s63, s58, 163840
    buffer_load_dwordx4 v41, s[44:47], s63 offen  lds
    s_add_u32 m0, s67, 4096
    s_add_u32 s63, s58, 262144
    buffer_load_dwordx4 v28, s[44:47], s63 offen  lds
    s_add_u32 m0, s67, 5120
    s_add_u32 s63, s58, 393216
    buffer_load_dwordx4 v41, s[44:47], s63 offen  lds
    s_add_u32 m0, s67, 6144
    s_add_u32 s63, s58, 294912
    buffer_load_dwordx4 v28, s[44:47], s63 offen  lds
    s_add_u32 m0, s67, 7168
    s_add_u32 s63, s58, 425984
    buffer_load_dwordx4 v41, s[44:47], s63 offen  lds
    s_mov_b32 s48, s22
    s_and_b32 s49, s23, 0xffff
    s_mov_b32 s50, 4194304
    s_mov_b32 s51, 0x20000
    v_lshrrev_b32 v25, 4, v24
    v_and_b32 v26, 15, v24
    v_lshlrev_b32 v0, 4, v24
    v_bfe_u32 v27, v24, 2, 1
    v_bfe_u32 v32, v24, 3, 1
    v_bfe_u32 v33, v24, 4, 1
    v_and_b32 v35, 3, v24
    v_lshlrev_b32 v29, 10, v25
    v_lshl_add_u32 v29, v26, 4, v29
    v_lshlrev_b32 v36, 6, v33
    v_xor_b32 v29, v36, v29
    v_xor_b32 v40, 128, v29
    v_lshrrev_b32 v36, 2, v24
    v_lshlrev_b32 v36, 7, v36
    v_lshl_add_u32 v36, v35, 3, v36
    s_and_b32 s63, s56, 1
    s_lshl_b32 s63, s63, 6
    v_add_u32 v36, s63, v36
    v_bfe_u32 v37, v24, 3, 2
    v_lshlrev_b32 v37, 5, v37
    v_xor_b32 v36, v37, v36
    v_add_u32 v30, s67, v36
    s_xor_b32 s64, s56, 1
    s_mul_i32 s64, s64, 36864
    v_add_u32 v31, s64, v36
    v_xor_b32 v42, 32, v30
    v_xor_b32 v43, 32, v31
    v_lshl_add_u32 v36, v33, 4, v27
    v_lshl_add_u32 v36, v34, 2, v36
    v_lshlrev_b32 v36, 8, v36
    v_lshl_add_u32 v36, v35, 3, v36
    v_lshl_add_u32 v36, v32, 5, v36
    s_and_b32 s63, s57, 3
    s_lshl_b32 s63, s63, 6
    s_add_u32 s63, s63, s67
    v_add_u32 v36, s63, v36
    v_lshl_add_u32 v37, v33, 1, v27
    v_lshlrev_b32 v37, 6, v37
    v_xor_b32 v36, v37, v36
    v_xor_b32 v37, 64, v36
    v_xor_b32 v38, 128, v36
    v_xor_b32 v39, 192, v36
    v_add_u32 v11, s67, v0
    s_lshl_b32 s63, s57, 17
    s_lshl_b32 s64, s56, 8
    s_add_u32 s4, s63, s64
    s_and_b32 s63, s57, 1
    s_lshl_b32 s63, s63, 11
    s_and_b32 s64, s57, 6
    s_lshl_b32 s64, s64, 12
    s_add_u32 s63, s63, s64
    s_lshr_b32 s64, s57, 3
    s_lshl_b32 s64, s64, 16
    s_add_u32 s63, s63, s64
    s_add_u32 s63, s63, s97
    s_add_u32 s79, s63, 4096
    s_add_u32 s80, s79, 32768
    s_and_b32 s64, s56, 1
    s_lshl_b32 s64, s64, 12
    s_add_u32 s81, s63, s64
    s_lshr_b32 s64, s56, 1
    s_lshl_b32 s64, s64, 15
    s_add_u32 s81, s81, s64
    s_add_u32 s81, s81, 0x40000
    s_lshl_b32 s63, s57, 8
    s_add_u32 s74, s63, s97
    s_add_u32 s74, s74, 1048576
    s_add_u32 s73, s74, 8192
    s_add_u32 s64, s97, 1114112
    s_lshl_b32 s3, s57, 2
    s_add_u32 s3, s3, s64
    s_lshl_b32 s63, s56, 8
    s_add_u32 s3, s63, s3
    s_and_b32 s85, s57, 3
    s_lshl_b32 s85, s85, 8
    s_add_u32 s85, s85, s64
    s_lshl_b32 s63, s57, 7
    s_add_u32 s7, s63, 64032768
    s_mov_b32 s44, s22
    s_and_b32 s45, s23, 0xffff
    s_xor_b32 s58, s68, 1
    s_lshl_b32 s58, s58, 19
    s_add_u32 s58, s58, s83
    s_add_u32 m0, s67, 8192
    s_add_u32 s63, s58, 0
    buffer_load_dwordx4 v28, s[44:47], s63 offen  lds
    s_add_u32 m0, s67, 9216
    s_add_u32 s63, s58, 131072
    buffer_load_dwordx4 v41, s[44:47], s63 offen  lds
    s_add_u32 m0, s67, 10240
    s_add_u32 s63, s58, 32768
    buffer_load_dwordx4 v28, s[44:47], s63 offen  lds
    s_add_u32 m0, s67, 11264
    s_add_u32 s63, s58, 163840
    buffer_load_dwordx4 v41, s[44:47], s63 offen  lds
    s_add_u32 m0, s67, 12288
    s_add_u32 s63, s58, 262144
    buffer_load_dwordx4 v28, s[44:47], s63 offen  lds
    s_add_u32 m0, s67, 13312
    s_add_u32 s63, s58, 393216
    buffer_load_dwordx4 v41, s[44:47], s63 offen  lds
    s_add_u32 m0, s67, 14336
    s_add_u32 s63, s58, 294912
    buffer_load_dwordx4 v28, s[44:47], s63 offen  lds
    s_add_u32 m0, s67, 15360
    s_add_u32 s63, s58, 425984
    buffer_load_dwordx4 v41, s[44:47], s63 offen  lds
    s_waitcnt vmcnt(8) lgkmcnt(0)
    s_barrier
    s_mov_b32 s44, s22
    s_and_b32 s45, s23, 0xffff
    s_xor_b32 s58, s68, 4
    s_lshl_b32 s58, s58, 19
    s_add_u32 s58, s58, s83
    s_add_u32 m0, s67, 16384
    s_add_u32 s63, s58, 0
    buffer_load_dwordx4 v28, s[44:47], s63 offen  lds
    s_add_u32 m0, s67, 17408
    s_add_u32 s63, s58, 131072
    buffer_load_dwordx4 v41, s[44:47], s63 offen  lds
    s_add_u32 m0, s67, 18432
    s_add_u32 s63, s58, 32768
    buffer_load_dwordx4 v28, s[44:47], s63 offen  lds
    s_add_u32 m0, s67, 19456
    s_add_u32 s63, s58, 163840
    buffer_load_dwordx4 v41, s[44:47], s63 offen  lds
    s_add_u32 m0, s67, 20480
    s_add_u32 s63, s58, 262144
    buffer_load_dwordx4 v28, s[44:47], s63 offen  lds
    s_add_u32 m0, s67, 21504
    s_add_u32 s63, s58, 393216
    buffer_load_dwordx4 v41, s[44:47], s63 offen  lds
    s_add_u32 m0, s67, 22528
    s_add_u32 s63, s58, 294912
    buffer_load_dwordx4 v28, s[44:47], s63 offen  lds
    s_add_u32 m0, s67, 23552
    s_add_u32 s63, s58, 425984
    buffer_load_dwordx4 v41, s[44:47], s63 offen  lds
    s_cmp_lg_u32 s56, 0
    s_cbranch_scc1 L_na_1
    s_lshr_b32 s64, s62, 3
    s_lshl_b32 s64, 1, s64
    s_and_b32 s65, s62, 7
    s_lshl_b32 s65, s65, 5
    s_cmp_eq_u32 s96, 0
    s_cselect_b32 s64, s64, 0
    s_cselect_b32 s65, s65, 136
    v_mov_b32 v46, s64
    v_mov_b32 v47, 256
    v_lshlrev_b32 v48, 20, v24
    buffer_atomic_add_x2 v[46:47], v48, s[40:43], s65 offen sc1
L_na_1:
    s_waitcnt lgkmcnt(0)
    ds_read_b64_tr_b16 a[128:129], v30 offset:0
    ds_read_b64_tr_b16 a[130:131], v30 offset:2048
    ds_read_b64_tr_b16 a[132:133], v30 offset:4096
    ds_read_b64_tr_b16 a[134:135], v30 offset:6144
    ds_read_b64_tr_b16 a[136:137], v42 offset:0
    ds_read_b64_tr_b16 a[138:139], v42 offset:2048
    ds_read_b64_tr_b16 a[140:141], v42 offset:4096
    ds_read_b64_tr_b16 a[142:143], v42 offset:6144
    s_waitcnt lgkmcnt(4)
    ds_read_b64_tr_b16 a[160:161], v31 offset:0
    ds_read_b64_tr_b16 a[162:163], v31 offset:2048
    ds_read_b64_tr_b16 a[164:165], v31 offset:4096
    ds_read_b64_tr_b16 a[166:167], v31 offset:6144
    ds_read_b64_tr_b16 a[168:169], v43 offset:0
    ds_read_b64_tr_b16 a[170:171], v43 offset:2048
    ds_read_b64_tr_b16 a[172:173], v43 offset:4096
    ds_read_b64_tr_b16 a[174:175], v43 offset:6144
    s_waitcnt vmcnt(8) lgkmcnt(0)
    s_barrier
    s_mov_b32 s44, s22
    s_and_b32 s45, s23, 0xffff
    s_xor_b32 s58, s68, 5
    s_lshl_b32 s58, s58, 19
    s_add_u32 s58, s58, s83
    s_add_u32 m0, s67, 24576
    s_add_u32 s63, s58, 0
    buffer_load_dwordx4 v28, s[44:47], s63 offen  lds
    s_add_u32 m0, s67, 25600
    s_add_u32 s63, s58, 131072
    buffer_load_dwordx4 v41, s[44:47], s63 offen  lds
    s_add_u32 m0, s67, 26624
    s_add_u32 s63, s58, 32768
    buffer_load_dwordx4 v28, s[44:47], s63 offen  lds
    s_add_u32 m0, s67, 27648
    s_add_u32 s63, s58, 163840
    buffer_load_dwordx4 v41, s[44:47], s63 offen  lds
    s_add_u32 m0, s67, 28672
    s_add_u32 s63, s58, 262144
    buffer_load_dwordx4 v28, s[44:47], s63 offen  lds
    s_add_u32 m0, s67, 29696
    s_add_u32 s63, s58, 393216
    buffer_load_dwordx4 v41, s[44:47], s63 offen  lds
    s_add_u32 m0, s67, 30720
    s_add_u32 s63, s58, 294912
    buffer_load_dwordx4 v28, s[44:47], s63 offen  lds
    s_add_u32 m0, s67, 31744
    s_add_u32 s63, s58, 425984
    buffer_load_dwordx4 v41, s[44:47], s63 offen  lds
    v_bfe_u32 v45, v24, 1, 1
    v_mov_b32 v46, 0x4444
    v_mov_b32 v47, 0xeeee
    v_cmp_eq_u32 vcc, 1, v45
    s_nop 1
    v_cndmask_b32 v15, v46, v47, vcc
    v_and_b32 v46, -3, v24
    s_lshl_b32 s64, s56, 10
    s_add_u32 s64, s64, 155648
    v_lshl_add_u32 v47, v35, 2, s64
    v_lshl_add_u32 v47, v27, 5, v47
    v_lshl_add_u32 v47, v25, 6, v47
    v_lshrrev_b32 v48, 2, v26
    v_lshl_add_u32 v6, v48, 8, v47
    v_mov_b32 v48, 262144
    v_lshrrev_b32 v47, 3, v24
    v_add_u32 v47, s56, v47
    v_and_b32 v47, 3, v47
    v_lshlrev_b32 v47, 2, v47
    v_lshl_add_u32 v47, v46, 4, v47
    v_add_u32 v47, 159744, v47
    v_cndmask_b32 v7, v48, v47, vcc
    v_xor_b32 v14, 32, v6
    v_add_u32 v8, 147456, v0
    v_lshlrev_b32 v47, 5, v33
    v_xor_b32 v10, v47, v8
    v_mov_b32 v9, -1
    s_xor_b32 s64, s56, 0
    s_lshl_b32 s64, s64, 11
    v_add_u32 v2, s64, v8
    s_xor_b32 s64, s56, 1
    s_lshl_b32 s64, s64, 11
    v_add_u32 v3, s64, v8
    s_xor_b32 s64, s56, 2
    s_lshl_b32 s64, s64, 11
    v_add_u32 v4, s64, v8
    s_xor_b32 s64, s56, 3
    s_lshl_b32 s64, s64, 11
    v_add_u32 v5, s64, v8
    v_lshlrev_b32 v1, 4, v27
    v_lshl_add_u32 v1, v33, 7, v1
    v_lshl_add_u32 v1, v45, 6, v1
    v_and_b32 v46, 1, v24
    v_lshl_add_u32 v1, v46, 5, v1
    v_lshl_add_u32 v1, v32, 8, v1
    v_lshl_add_u32 v1, v34, 9, v1
    v_and_b32 v46, 31, v24
    v_lshlrev_b32 v12, 2, v46
    v_lshl_add_u32 v12, v34, 11, v12
    s_lshl_b32 s71, s68, 10
    s_xor_b32 s72, s71, 1024
    s_add_u32 s64, s97, 1048576
    s_add_u32 s71, s71, s64
    s_add_u32 s72, s72, s64
    s_xor_b32 s64, s57, 0
    s_and_b32 s64, s64, 3
    s_lshr_b32 s65, s57, 3
    s_xor_b32 s65, s65, s64
    s_xor_b32 s65, s65, s56
    s_lshl_b32 s65, s65, 9
    s_lshl_b32 s64, s64, 13
    s_add_u32 s64, s64, s65
    s_lshl_b32 s65, s56, 16
    s_add_u32 s64, s64, s65
    s_and_b32 s65, s57, 4
    s_lshl_b32 s65, s65, 5
    s_add_u32 s64, s64, s65
    s_add_u32 s64, s64, 0
    s_add_u32 s75, s64, s97
    s_xor_b32 s64, s57, 1
    s_and_b32 s64, s64, 3
    s_lshr_b32 s65, s57, 3
    s_xor_b32 s65, s65, s64
    s_xor_b32 s65, s65, s56
    s_lshl_b32 s65, s65, 9
    s_lshl_b32 s64, s64, 13
    s_add_u32 s64, s64, s65
    s_lshl_b32 s65, s56, 16
    s_add_u32 s64, s64, s65
    s_and_b32 s65, s57, 4
    s_lshl_b32 s65, s65, 5
    s_add_u32 s64, s64, s65
    s_add_u32 s64, s64, 4096
    s_add_u32 s76, s64, s97
    s_xor_b32 s64, s57, 2
    s_and_b32 s64, s64, 3
    s_lshr_b32 s65, s57, 3
    s_xor_b32 s65, s65, s64
    s_xor_b32 s65, s65, s56
    s_lshl_b32 s65, s65, 9
    s_lshl_b32 s64, s64, 13
    s_add_u32 s64, s64, s65
    s_lshl_b32 s65, s56, 16
    s_add_u32 s64, s64, s65
    s_and_b32 s65, s57, 4
    s_lshl_b32 s65, s65, 5
    s_add_u32 s64, s64, s65
    s_add_u32 s64, s64, 32768
    s_add_u32 s77, s64, s97
    s_xor_b32 s64, s57, 3
    s_and_b32 s64, s64, 3
    s_lshr_b32 s65, s57, 3
    s_xor_b32 s65, s65, s64
    s_xor_b32 s65, s65, s56
    s_lshl_b32 s65, s65, 9
    s_lshl_b32 s64, s64, 13
    s_add_u32 s64, s64, s65
    s_lshl_b32 s65, s56, 16
    s_add_u32 s64, s64, s65
    s_and_b32 s65, s57, 4
    s_lshl_b32 s65, s65, 5
    s_add_u32 s64, s64, s65
    s_add_u32 s64, s64, 36864
    s_add_u32 s78, s64, s97
    v_lshlrev_b32 v46, 2, v25
    v_sub_u32 v46, v26, v46
    v_mov_b32 v47, 0x3f80
    v_mov_b32 v48, 0x3f800000
    v_mov_b32 v16, 0
    v_mov_b32 v17, 0
    v_cmp_eq_u32 vcc, 0, v46
    s_nop 1
    v_cndmask_b32 v16, v16, v47, vcc
    v_cmp_eq_u32 vcc, 1, v46
    s_nop 1
    v_cndmask_b32 v16, v16, v48, vcc
    v_cmp_eq_u32 vcc, 2, v46
    s_nop 1
    v_cndmask_b32 v17, v17, v47, vcc
    v_cmp_eq_u32 vcc, 3, v46
    s_nop 1
    v_cndmask_b32 v17, v17, v48, vcc
    v_mov_b32 v21, 0
    v_mov_b32 v22, 0
    v_mov_b32 v52, 0
    v_cmp_eq_u32 vcc, 0, v26
    s_nop 1
    v_cndmask_b32 v52, v52, v47, vcc
    v_cmp_eq_u32 vcc, 8, v26
    s_nop 1
    v_cndmask_b32 v52, v52, v48, vcc
    v_mov_b32 v53, 0
    v_cmp_eq_u32 vcc, 1, v26
    s_nop 1
    v_cndmask_b32 v53, v53, v47, vcc
    v_cmp_eq_u32 vcc, 9, v26
    s_nop 1
    v_cndmask_b32 v53, v53, v48, vcc
    v_mov_b32 v54, 0
    v_cmp_eq_u32 vcc, 4, v26
    s_nop 1
    v_cndmask_b32 v54, v54, v47, vcc
    v_cmp_eq_u32 vcc, 12, v26
    s_nop 1
    v_cndmask_b32 v54, v54, v48, vcc
    v_mov_b32 v55, 0
    v_cmp_eq_u32 vcc, 5, v26
    s_nop 1
    v_cndmask_b32 v55, v55, v47, vcc
    v_cmp_eq_u32 vcc, 13, v26
    s_nop 1
    v_cndmask_b32 v55, v55, v48, vcc
    ds_write_b128 v8, v[52:55] offset:13312
    s_waitcnt lgkmcnt(0)
    v_lshlrev_b32 v13, 2, v24
    s_mov_b32 s0, 0x33333333
    s_mov_b32 s1, 0x33333333
    s_mov_b32 s84, 0x3e0293ee
    s_waitcnt lgkmcnt(0)
    ds_read_b64_tr_b16 a[144:145], v30 offset:8192
    ds_read_b64_tr_b16 a[146:147], v30 offset:10240
    ds_read_b64_tr_b16 a[148:149], v30 offset:12288
    ds_read_b64_tr_b16 a[150:151], v30 offset:14336
    ds_read_b64_tr_b16 a[152:153], v42 offset:8192
    ds_read_b64_tr_b16 a[154:155], v42 offset:10240
    ds_read_b64_tr_b16 a[156:157], v42 offset:12288
    ds_read_b64_tr_b16 a[158:159], v42 offset:14336
    s_waitcnt lgkmcnt(4)
    ds_read_b64_tr_b16 a[176:177], v31 offset:8192
    ds_read_b64_tr_b16 a[178:179], v31 offset:10240
    ds_read_b64_tr_b16 a[180:181], v31 offset:12288
    ds_read_b64_tr_b16 a[182:183], v31 offset:14336
    ds_read_b64_tr_b16 a[184:185], v43 offset:8192
    ds_read_b64_tr_b16 a[186:187], v43 offset:10240
    ds_read_b64_tr_b16 a[188:189], v43 offset:12288
    ds_read_b64_tr_b16 a[190:191], v43 offset:14336
    s_waitcnt vmcnt(8) lgkmcnt(0)
    s_barrier
    s_mov_b32 s44, s24
    s_and_b32 s45, s25, 0xffff
    s_xor_b32 s58, s68, 5
    s_lshl_b32 s58, s58, 19
    s_add_u32 s58, s58, s83
    s_add_u32 m0, s67, 0
    s_add_u32 s63, s58, 0
    buffer_load_dwordx4 v28, s[44:47], s63 offen  lds
    s_add_u32 m0, s67, 1024
    s_add_u32 s63, s58, 131072
    buffer_load_dwordx4 v41, s[44:47], s63 offen  lds
    s_add_u32 m0, s67, 2048
    s_add_u32 s63, s58, 32768
    buffer_load_dwordx4 v28, s[44:47], s63 offen  lds
    s_add_u32 m0, s67, 3072
    s_add_u32 s63, s58, 163840
    buffer_load_dwordx4 v41, s[44:47], s63 offen  lds
    s_add_u32 m0, s67, 4096
    s_add_u32 s63, s58, 262144
    buffer_load_dwordx4 v28, s[44:47], s63 offen  lds
    s_add_u32 m0, s67, 5120
    s_add_u32 s63, s58, 393216
    buffer_load_dwordx4 v41, s[44:47], s63 offen  lds
    s_add_u32 m0, s67, 6144
    s_add_u32 s63, s58, 294912
    buffer_load_dwordx4 v28, s[44:47], s63 offen  lds
    s_add_u32 m0, s67, 7168
    s_add_u32 s63, s58, 425984
    buffer_load_dwordx4 v41, s[44:47], s63 offen  lds
    s_waitcnt lgkmcnt(0)
    ds_read_b64_tr_b16 a[192:193], v30 offset:16384
    ds_read_b64_tr_b16 a[194:195], v30 offset:18432
    ds_read_b64_tr_b16 a[196:197], v30 offset:20480
    ds_read_b64_tr_b16 a[198:199], v30 offset:22528
    ds_read_b64_tr_b16 a[200:201], v42 offset:16384
    ds_read_b64_tr_b16 a[202:203], v42 offset:18432
    ds_read_b64_tr_b16 a[204:205], v42 offset:20480
    ds_read_b64_tr_b16 a[206:207], v42 offset:22528
    s_waitcnt lgkmcnt(4)
    ds_read_b64_tr_b16 a[224:225], v31 offset:16384
    ds_read_b64_tr_b16 a[226:227], v31 offset:18432
    ds_read_b64_tr_b16 a[228:229], v31 offset:20480
    ds_read_b64_tr_b16 a[230:231], v31 offset:22528
    ds_read_b64_tr_b16 a[232:233], v43 offset:16384
    ds_read_b64_tr_b16 a[234:235], v43 offset:18432
    ds_read_b64_tr_b16 a[236:237], v43 offset:20480
    ds_read_b64_tr_b16 a[238:239], v43 offset:22528
    s_waitcnt vmcnt(8) lgkmcnt(0)
    s_barrier
    s_mov_b32 s44, s24
    s_and_b32 s45, s25, 0xffff
    s_xor_b32 s58, s68, 4
    s_lshl_b32 s58, s58, 19
    s_add_u32 s58, s58, s83
    s_add_u32 m0, s67, 8192
    s_add_u32 s63, s58, 0
    buffer_load_dwordx4 v28, s[44:47], s63 offen  lds
    s_add_u32 m0, s67, 9216
    s_add_u32 s63, s58, 131072
    buffer_load_dwordx4 v41, s[44:47], s63 offen  lds
    s_add_u32 m0, s67, 10240
    s_add_u32 s63, s58, 32768
    buffer_load_dwordx4 v28, s[44:47], s63 offen  lds
    s_add_u32 m0, s67, 11264
    s_add_u32 s63, s58, 163840
    buffer_load_dwordx4 v41, s[44:47], s63 offen  lds
    s_add_u32 m0, s67, 12288
    s_add_u32 s63, s58, 262144
    buffer_load_dwordx4 v28, s[44:47], s63 offen  lds
    s_add_u32 m0, s67, 13312
    s_add_u32 s63, s58, 393216
    buffer_load_dwordx4 v41, s[44:47], s63 offen  lds
    s_add_u32 m0, s67, 14336
    s_add_u32 s63, s58, 294912
    buffer_load_dwordx4 v28, s[44:47], s63 offen  lds
    s_add_u32 m0, s67, 15360
    s_add_u32 s63, s58, 425984
    buffer_load_dwordx4 v41, s[44:47], s63 offen  lds
    s_waitcnt lgkmcnt(0)
    ds_read_b64_tr_b16 a[208:209], v30 offset:24576
    ds_read_b64_tr_b16 a[210:211], v30 offset:26624
    ds_read_b64_tr_b16 a[212:213], v30 offset:28672
    ds_read_b64_tr_b16 a[214:215], v30 offset:30720
    ds_read_b64_tr_b16 a[216:217], v42 offset:24576
    ds_read_b64_tr_b16 a[218:219], v42 offset:26624
    ds_read_b64_tr_b16 a[220:221], v42 offset:28672
    ds_read_b64_tr_b16 a[222:223], v42 offset:30720
    s_waitcnt lgkmcnt(4)
    ds_read_b64_tr_b16 a[240:241], v31 offset:24576
    ds_read_b64_tr_b16 a[242:243], v31 offset:26624
    ds_read_b64_tr_b16 a[244:245], v31 offset:28672
    ds_read_b64_tr_b16 a[246:247], v31 offset:30720
    ds_read_b64_tr_b16 a[248:249], v43 offset:24576
    ds_read_b64_tr_b16 a[250:251], v43 offset:26624
    ds_read_b64_tr_b16 a[252:253], v43 offset:28672
    ds_read_b64_tr_b16 a[254:255], v43 offset:30720
    s_waitcnt vmcnt(8) lgkmcnt(0)
    s_barrier
    s_mov_b32 s44, s20
    s_and_b32 s45, s21, 0xffff
    s_xor_b32 s58, s68, 0
    s_lshl_b32 s58, s58, 19
    s_add_u32 s58, s58, s83
    s_add_u32 m0, s67, 16384
    s_add_u32 s63, s58, 0
    buffer_load_dwordx4 v28, s[44:47], s63 offen  lds
    s_add_u32 m0, s67, 17408
    s_add_u32 s63, s58, 131072
    buffer_load_dwordx4 v41, s[44:47], s63 offen  lds
    s_add_u32 m0, s67, 18432
    s_add_u32 s63, s58, 32768
    buffer_load_dwordx4 v28, s[44:47], s63 offen  lds
    s_add_u32 m0, s67, 19456
    s_add_u32 s63, s58, 163840
    buffer_load_dwordx4 v41, s[44:47], s63 offen  lds
    s_add_u32 m0, s67, 20480
    s_add_u32 s63, s58, 262144
    buffer_load_dwordx4 v28, s[44:47], s63 offen  lds
    s_add_u32 m0, s67, 21504
    s_add_u32 s63, s58, 393216
    buffer_load_dwordx4 v41, s[44:47], s63 offen  lds
    s_add_u32 m0, s67, 22528
    s_add_u32 s63, s58, 294912
    buffer_load_dwordx4 v28, s[44:47], s63 offen  lds
    s_add_u32 m0, s67, 23552
    s_add_u32 s63, s58, 425984
    buffer_load_dwordx4 v41, s[44:47], s63 offen  lds
    s_waitcnt lgkmcnt(0)
    ds_read_b64_tr_b16 v[160:161], v30 offset:0
    ds_read_b64_tr_b16 v[162:163], v30 offset:2048
    ds_read_b64_tr_b16 v[164:165], v30 offset:4096
    ds_read_b64_tr_b16 v[166:167], v30 offset:6144
    ds_read_b64_tr_b16 v[168:169], v42 offset:0
    ds_read_b64_tr_b16 v[170:171], v42 offset:2048
    ds_read_b64_tr_b16 v[172:173], v42 offset:4096
    ds_read_b64_tr_b16 v[174:175], v42 offset:6144
    s_waitcnt lgkmcnt(4)
    ds_read_b64_tr_b16 v[192:193], v31 offset:0
    ds_read_b64_tr_b16 v[194:195], v31 offset:2048
    ds_read_b64_tr_b16 v[196:197], v31 offset:4096
    ds_read_b64_tr_b16 v[198:199], v31 offset:6144
    ds_read_b64_tr_b16 v[200:201], v43 offset:0
    ds_read_b64_tr_b16 v[202:203], v43 offset:2048
    ds_read_b64_tr_b16 v[204:205], v43 offset:4096
    ds_read_b64_tr_b16 v[206:207], v43 offset:6144
    s_waitcnt vmcnt(8) lgkmcnt(0)
    s_barrier
    s_mov_b32 s44, s20
    s_and_b32 s45, s21, 0xffff
    s_xor_b32 s58, s68, 1
    s_lshl_b32 s58, s58, 19
    s_add_u32 s58, s58, s83
    s_add_u32 m0, s67, 24576
    s_add_u32 s63, s58, 0
    buffer_load_dwordx4 v28, s[44:47], s63 offen  lds
    s_add_u32 m0, s67, 25600
    s_add_u32 s63, s58, 131072
    buffer_load_dwordx4 v41, s[44:47], s63 offen  lds
    s_add_u32 m0, s67, 26624
    s_add_u32 s63, s58, 32768
    buffer_load_dwordx4 v28, s[44:47], s63 offen  lds
    s_add_u32 m0, s67, 27648
    s_add_u32 s63, s58, 163840
    buffer_load_dwordx4 v41, s[44:47], s63 offen  lds
    s_add_u32 m0, s67, 28672
    s_add_u32 s63, s58, 262144
    buffer_load_dwordx4 v28, s[44:47], s63 offen  lds
    s_add_u32 m0, s67, 29696
    s_add_u32 s63, s58, 393216
    buffer_load_dwordx4 v41, s[44:47], s63 offen  lds
    s_add_u32 m0, s67, 30720
    s_add_u32 s63, s58, 294912
    buffer_load_dwordx4 v28, s[44:47], s63 offen  lds
    s_add_u32 m0, s67, 31744
    s_add_u32 s63, s58, 425984
    buffer_load_dwordx4 v41, s[44:47], s63 offen  lds
    s_waitcnt lgkmcnt(0)
    ds_read_b64_tr_b16 v[144:145], v30 offset:8192
    ds_read_b64_tr_b16 v[146:147], v30 offset:10240
    ds_read_b64_tr_b16 v[148:149], v30 offset:12288
    ds_read_b64_tr_b16 v[150:151], v30 offset:14336
    ds_read_b64_tr_b16 v[152:153], v42 offset:8192
    ds_read_b64_tr_b16 v[154:155], v42 offset:10240
    ds_read_b64_tr_b16 v[156:157], v42 offset:12288
    ds_read_b64_tr_b16 v[158:159], v42 offset:14336
    s_waitcnt lgkmcnt(4)
    ds_read_b64_tr_b16 v[176:177], v31 offset:8192
    ds_read_b64_tr_b16 v[178:179], v31 offset:10240
    ds_read_b64_tr_b16 v[180:181], v31 offset:12288
    ds_read_b64_tr_b16 v[182:183], v31 offset:14336
    ds_read_b64_tr_b16 v[184:185], v43 offset:8192
    ds_read_b64_tr_b16 v[186:187], v43 offset:10240
    ds_read_b64_tr_b16 v[188:189], v43 offset:12288
    ds_read_b64_tr_b16 v[190:191], v43 offset:14336
    s_waitcnt vmcnt(8) lgkmcnt(0)
    s_barrier
    s_mov_b32 s44, s20
    s_and_b32 s45, s21, 0xffff
    s_xor_b32 s58, s68, 4
    s_lshl_b32 s58, s58, 19
    s_add_u32 s58, s58, s83
    s_add_u32 m0, s67, 0
    s_add_u32 s63, s58, 0
    buffer_load_dwordx4 v28, s[44:47], s63 offen  lds
    s_add_u32 m0, s67, 1024
    s_add_u32 s63, s58, 131072
    buffer_load_dwordx4 v41, s[44:47], s63 offen  lds
    s_add_u32 m0, s67, 2048
    s_add_u32 s63, s58, 32768
    buffer_load_dwordx4 v28, s[44:47], s63 offen  lds
    s_add_u32 m0, s67, 3072
    s_add_u32 s63, s58, 163840
    buffer_load_dwordx4 v41, s[44:47], s63 offen  lds
    s_add_u32 m0, s67, 4096
    s_add_u32 s63, s58, 262144
    buffer_load_dwordx4 v28, s[44:47], s63 offen  lds
    s_add_u32 m0, s67, 5120
    s_add_u32 s63, s58, 393216
    buffer_load_dwordx4 v41, s[44:47], s63 offen  lds
    s_add_u32 m0, s67, 6144
    s_add_u32 s63, s58, 294912
    buffer_load_dwordx4 v28, s[44:47], s63 offen  lds
    s_add_u32 m0, s67, 7168
    s_add_u32 s63, s58, 425984
    buffer_load_dwordx4 v41, s[44:47], s63 offen  lds
    v_and_b32 v58, 7, v24
    v_lshlrev_b32 v58, 5, v58
    s_cmp_eq_u32 s96, 0
    s_cselect_b32 s63, 0, 8
    v_add_u32 v58, s63, v58
    buffer_load_dwordx2 v[56:57], v58, s[40:43], 0 offen sc1
    s_mov_b32 s52, s18
    s_and_b32 s53, s19, 0xffff
    s_mov_b32 s54, 8192
    s_mov_b32 s55, 0x20000
    v_lshrrev_b32 v60, 2, v26
    v_lshlrev_b32 v60, 1, v60
    v_and_or_b32 v60, v24, 1, v60
    v_lshlrev_b32 v60, 10, v60
    v_lshl_add_u32 v60, v25, 5, v60
    v_bfe_u32 v61, v24, 1, 1
    v_lshl_add_u32 v60, v61, 2, v60
    s_lshl_b32 s63, s68, 7
    s_xor_b32 s64, s63, 128
    buffer_load_dword v64, v60, s[52:55], s63 offen offset:0
    buffer_load_dword v68, v60, s[52:55], s64 offen offset:0
    buffer_load_dword v65, v60, s[52:55], s63 offen offset:8
    buffer_load_dword v69, v60, s[52:55], s64 offen offset:8
    buffer_load_dword v66, v60, s[52:55], s63 offen offset:16
    buffer_load_dword v70, v60, s[52:55], s64 offen offset:16
    buffer_load_dword v67, v60, s[52:55], s63 offen offset:24
    buffer_load_dword v71, v60, s[52:55], s64 offen offset:24
    s_waitcnt lgkmcnt(0)
    ds_read_b64_tr_b16 a[0:1], v30 offset:16384
    ds_read_b64_tr_b16 a[2:3], v30 offset:18432
    ds_read_b64_tr_b16 a[4:5], v30 offset:20480
    ds_read_b64_tr_b16 a[6:7], v30 offset:22528
    ds_read_b64_tr_b16 a[8:9], v42 offset:16384
    ds_read_b64_tr_b16 a[10:11], v42 offset:18432
    ds_read_b64_tr_b16 a[12:13], v42 offset:20480
    ds_read_b64_tr_b16 a[14:15], v42 offset:22528
    s_waitcnt lgkmcnt(4)
    ds_read_b64_tr_b16 a[32:33], v31 offset:16384
    ds_read_b64_tr_b16 a[34:35], v31 offset:18432
    ds_read_b64_tr_b16 a[36:37], v31 offset:20480
    ds_read_b64_tr_b16 a[38:39], v31 offset:22528
    ds_read_b64_tr_b16 a[40:41], v43 offset:16384
    ds_read_b64_tr_b16 a[42:43], v43 offset:18432
    ds_read_b64_tr_b16 a[44:45], v43 offset:20480
    ds_read_b64_tr_b16 a[46:47], v43 offset:22528
    s_waitcnt vmcnt(8) lgkmcnt(0)
    s_barrier
    s_mov_b32 s44, s20
    s_and_b32 s45, s21, 0xffff
    s_xor_b32 s58, s68, 5
    s_lshl_b32 s58, s58, 19
    s_add_u32 s58, s58, s83
    s_add_u32 m0, s67, 8192
    s_add_u32 s63, s58, 0
    buffer_load_dwordx4 v28, s[44:47], s63 offen  lds
    s_add_u32 m0, s67, 9216
    s_add_u32 s63, s58, 131072
    buffer_load_dwordx4 v41, s[44:47], s63 offen  lds
    s_add_u32 m0, s67, 10240
    s_add_u32 s63, s58, 32768
    buffer_load_dwordx4 v28, s[44:47], s63 offen  lds
    s_add_u32 m0, s67, 11264
    s_add_u32 s63, s58, 163840
    buffer_load_dwordx4 v41, s[44:47], s63 offen  lds
    s_add_u32 m0, s67, 12288
    s_add_u32 s63, s58, 262144
    buffer_load_dwordx4 v28, s[44:47], s63 offen  lds
    s_add_u32 m0, s67, 13312
    s_add_u32 s63, s58, 393216
    buffer_load_dwordx4 v41, s[44:47], s63 offen  lds
    s_add_u32 m0, s67, 14336
    s_add_u32 s63, s58, 294912
    buffer_load_dwordx4 v28, s[44:47], s63 offen  lds
    s_add_u32 m0, s67, 15360
    s_add_u32 s63, s58, 425984
    buffer_load_dwordx4 v41, s[44:47], s63 offen  lds
    s_waitcnt lgkmcnt(0)
    ds_read_b64_tr_b16 a[16:17], v30 offset:24576
    ds_read_b64_tr_b16 a[18:19], v30 offset:26624
    ds_read_b64_tr_b16 a[20:21], v30 offset:28672
    ds_read_b64_tr_b16 a[22:23], v30 offset:30720
    ds_read_b64_tr_b16 a[24:25], v42 offset:24576
    ds_read_b64_tr_b16 a[26:27], v42 offset:26624
    ds_read_b64_tr_b16 a[28:29], v42 offset:28672
    ds_read_b64_tr_b16 a[30:31], v42 offset:30720
    s_waitcnt lgkmcnt(4)
    ds_read_b64_tr_b16 a[48:49], v31 offset:24576
    ds_read_b64_tr_b16 a[50:51], v31 offset:26624
    ds_read_b64_tr_b16 a[52:53], v31 offset:28672
    ds_read_b64_tr_b16 a[54:55], v31 offset:30720
    ds_read_b64_tr_b16 a[56:57], v43 offset:24576
    ds_read_b64_tr_b16 a[58:59], v43 offset:26624
    ds_read_b64_tr_b16 a[60:61], v43 offset:28672
    ds_read_b64_tr_b16 a[62:63], v43 offset:30720
    s_waitcnt vmcnt(8) lgkmcnt(0)
    s_barrier
    s_mov_b32 s44, s26
    s_and_b32 s45, s27, 0xffff
    s_xor_b32 s58, s56, 1
    s_lshl_b32 s58, s58, 15
    s_add_u32 s58, s58, s4
    s_add_u32 m0, s67, 16384
    s_add_u32 s63, s58, 0
    buffer_load_dwordx4 v29, s[44:47], s63 offen  lds
    s_add_u32 m0, s67, 17408
    s_add_u32 s63, s58, 4096
    buffer_load_dwordx4 v29, s[44:47], s63 offen  lds
    s_add_u32 m0, s67, 18432
    s_add_u32 s63, s58, 8192
    buffer_load_dwordx4 v29, s[44:47], s63 offen  lds
    s_add_u32 m0, s67, 19456
    s_add_u32 s63, s58, 12288
    buffer_load_dwordx4 v29, s[44:47], s63 offen  lds
    s_add_u32 m0, s67, 20480
    s_add_u32 s63, s58, 16384
    buffer_load_dwordx4 v40, s[44:47], s63 offen  lds
    s_add_u32 m0, s67, 21504
    s_add_u32 s63, s58, 20480
    buffer_load_dwordx4 v40, s[44:47], s63 offen  lds
    s_add_u32 m0, s67, 22528
    s_add_u32 s63, s58, 24576
    buffer_load_dwordx4 v40, s[44:47], s63 offen  lds
    s_add_u32 m0, s67, 23552
    s_add_u32 s63, s58, 28672
    buffer_load_dwordx4 v40, s[44:47], s63 offen  lds
    s_waitcnt lgkmcnt(0)
    ds_read_b64_tr_b16 a[64:65], v30 offset:0
    ds_read_b64_tr_b16 a[66:67], v30 offset:2048
    ds_read_b64_tr_b16 a[68:69], v30 offset:4096
    ds_read_b64_tr_b16 a[70:71], v30 offset:6144
    ds_read_b64_tr_b16 a[72:73], v42 offset:0
    ds_read_b64_tr_b16 a[74:75], v42 offset:2048
    ds_read_b64_tr_b16 a[76:77], v42 offset:4096
    ds_read_b64_tr_b16 a[78:79], v42 offset:6144
    s_waitcnt lgkmcnt(4)
    ds_read_b64_tr_b16 a[96:97], v31 offset:0
    ds_read_b64_tr_b16 a[98:99], v31 offset:2048
    ds_read_b64_tr_b16 a[100:101], v31 offset:4096
    ds_read_b64_tr_b16 a[102:103], v31 offset:6144
    ds_read_b64_tr_b16 a[104:105], v43 offset:0
    ds_read_b64_tr_b16 a[106:107], v43 offset:2048
    ds_read_b64_tr_b16 a[108:109], v43 offset:4096
    ds_read_b64_tr_b16 a[110:111], v43 offset:6144
    s_waitcnt vmcnt(8) lgkmcnt(0)
    s_barrier
    s_mov_b32 s44, s26
    s_and_b32 s45, s27, 0xffff
    s_xor_b32 s58, s56, 2
    s_lshl_b32 s58, s58, 15
    s_add_u32 s58, s58, s4
    s_add_u32 m0, s67, 24576
    s_add_u32 s63, s58, 0
    buffer_load_dwordx4 v29, s[44:47], s63 offen  lds
    s_add_u32 m0, s67, 25600
    s_add_u32 s63, s58, 4096
    buffer_load_dwordx4 v29, s[44:47], s63 offen  lds
    s_add_u32 m0, s67, 26624
    s_add_u32 s63, s58, 8192
    buffer_load_dwordx4 v29, s[44:47], s63 offen  lds
    s_add_u32 m0, s67, 27648
    s_add_u32 s63, s58, 12288
    buffer_load_dwordx4 v29, s[44:47], s63 offen  lds
    s_add_u32 m0, s67, 28672
    s_add_u32 s63, s58, 16384
    buffer_load_dwordx4 v40, s[44:47], s63 offen  lds
    s_add_u32 m0, s67, 29696
    s_add_u32 s63, s58, 20480
    buffer_load_dwordx4 v40, s[44:47], s63 offen  lds
    s_add_u32 m0, s67, 30720
    s_add_u32 s63, s58, 24576
    buffer_load_dwordx4 v40, s[44:47], s63 offen  lds
    s_add_u32 m0, s67, 31744
    s_add_u32 s63, s58, 28672
    buffer_load_dwordx4 v40, s[44:47], s63 offen  lds
    s_waitcnt lgkmcnt(0)
    ds_read_b64_tr_b16 a[80:81], v30 offset:8192
    ds_read_b64_tr_b16 a[82:83], v30 offset:10240
    ds_read_b64_tr_b16 a[84:85], v30 offset:12288
    ds_read_b64_tr_b16 a[86:87], v30 offset:14336
    ds_read_b64_tr_b16 a[88:89], v42 offset:8192
    ds_read_b64_tr_b16 a[90:91], v42 offset:10240
    ds_read_b64_tr_b16 a[92:93], v42 offset:12288
    ds_read_b64_tr_b16 a[94:95], v42 offset:14336
    s_waitcnt lgkmcnt(4)
    ds_read_b64_tr_b16 a[112:113], v31 offset:8192
    ds_read_b64_tr_b16 a[114:115], v31 offset:10240
    ds_read_b64_tr_b16 a[116:117], v31 offset:12288
    ds_read_b64_tr_b16 a[118:119], v31 offset:14336
    ds_read_b64_tr_b16 a[120:121], v43 offset:8192
    ds_read_b64_tr_b16 a[122:123], v43 offset:10240
    ds_read_b64_tr_b16 a[124:125], v43 offset:12288
    ds_read_b64_tr_b16 a[126:127], v43 offset:14336
    s_waitcnt vmcnt(8) lgkmcnt(0)
    s_barrier
    s_mov_b32 s44, s24
    s_and_b32 s45, s25, 0xffff
    s_xor_b32 s58, s68, 0
    s_lshl_b32 s58, s58, 19
    s_add_u32 s58, s58, s83
    s_add_u32 m0, s67, 0
    s_add_u32 s63, s58, 0
    buffer_load_dwordx4 v28, s[44:47], s63 offen  lds
    s_add_u32 m0, s67, 1024
    s_add_u32 s63, s58, 131072
    buffer_load_dwordx4 v41, s[44:47], s63 offen  lds
    s_add_u32 m0, s67, 2048
    s_add_u32 s63, s58, 32768
    buffer_load_dwordx4 v28, s[44:47], s63 offen  lds
    s_add_u32 m0, s67, 3072
    s_add_u32 s63, s58, 163840
    buffer_load_dwordx4 v41, s[44:47], s63 offen  lds
    s_add_u32 m0, s67, 4096
    s_add_u32 s63, s58, 262144
    buffer_load_dwordx4 v28, s[44:47], s63 offen  lds
    s_add_u32 m0, s67, 5120
    s_add_u32 s63, s58, 393216
    buffer_load_dwordx4 v41, s[44:47], s63 offen  lds
    s_add_u32 m0, s67, 6144
    s_add_u32 s63, s58, 294912
    buffer_load_dwordx4 v28, s[44:47], s63 offen  lds
    s_add_u32 m0, s67, 7168
    s_add_u32 s63, s58, 425984
    buffer_load_dwordx4 v41, s[44:47], s63 offen  lds
L_arr_3:
    s_mov_b32 s64, 0
    v_readlane_b32 s63, v57, 0
    s_nop 0
    s_lshr_b32 s63, s63, 8
    s_add_u32 s64, s64, s63
    v_readlane_b32 s63, v57, 1
    s_nop 0
    s_lshr_b32 s63, s63, 8
    s_add_u32 s64, s64, s63
    v_readlane_b32 s63, v57, 2
    s_nop 0
    s_lshr_b32 s63, s63, 8
    s_add_u32 s64, s64, s63
    v_readlane_b32 s63, v57, 3
    s_nop 0
    s_lshr_b32 s63, s63, 8
    s_add_u32 s64, s64, s63
    v_readlane_b32 s63, v57, 4
    s_nop 0
    s_lshr_b32 s63, s63, 8
    s_add_u32 s64, s64, s63
    v_readlane_b32 s63, v57, 5
    s_nop 0
    s_lshr_b32 s63, s63, 8
    s_add_u32 s64, s64, s63
    v_readlane_b32 s63, v57, 6
    s_nop 0
    s_lshr_b32 s63, s63, 8
    s_add_u32 s64, s64, s63
    v_readlane_b32 s63, v57, 7
    s_nop 0
    s_lshr_b32 s63, s63, 8
    s_add_u32 s64, s64, s63
    s_cmp_ge_u32 s64, 256
    s_cbranch_scc1 L_arrd_4
    buffer_load_dwordx2 v[56:57], v58, s[40:43], 0 offen sc1
    s_sub_u32 s61, s61, 1
    s_cbranch_scc1 L_END
    s_waitcnt vmcnt(0)
    s_branch L_arr_3
L_arrd_4:
    s_cmp_lg_u32 s96, 0
    s_cbranch_scc1 L_arrk_5
    v_cmp_ne_u32 vcc, -1, v56
    s_cbranch_vccnz L_RESTART
    v_cmp_ne_u32 vcc, 8192, v57
    s_cbranch_vccnz L_RESTART
L_arrk_5:
    s_waitcnt lgkmcnt(0)
    ds_read_b64_tr_b16 v[208:209], v36 offset:16384
    ds_read_b64_tr_b16 v[210:211], v36 offset:16896
    ds_read_b64_tr_b16 v[212:213], v36 offset:18432
    ds_read_b64_tr_b16 v[214:215], v36 offset:18944
    ds_read_b64_tr_b16 v[216:217], v37 offset:16384
    ds_read_b64_tr_b16 v[218:219], v37 offset:16896
    ds_read_b64_tr_b16 v[220:221], v37 offset:18432
    ds_read_b64_tr_b16 v[222:223], v37 offset:18944
    s_waitcnt lgkmcnt(4)
    ds_read_b64_tr_b16 v[224:225], v38 offset:16384
    ds_read_b64_tr_b16 v[226:227], v38 offset:16896
    ds_read_b64_tr_b16 v[228:229], v38 offset:18432
    ds_read_b64_tr_b16 v[230:231], v38 offset:18944
    ds_read_b64_tr_b16 v[232:233], v39 offset:16384
    ds_read_b64_tr_b16 v[234:235], v39 offset:16896
    ds_read_b64_tr_b16 v[236:237], v39 offset:18432
    ds_read_b64_tr_b16 v[238:239], v39 offset:18944
    s_waitcnt vmcnt(8) lgkmcnt(0)
    s_barrier
    s_mov_b32 s44, s24
    s_and_b32 s45, s25, 0xffff
    s_xor_b32 s58, s68, 1
    s_lshl_b32 s58, s58, 19
    s_add_u32 s58, s58, s83
    s_add_u32 m0, s67, 8192
    s_add_u32 s63, s58, 0
    buffer_load_dwordx4 v28, s[44:47], s63 offen  lds
    s_add_u32 m0, s67, 9216
    s_add_u32 s63, s58, 131072
    buffer_load_dwordx4 v41, s[44:47], s63 offen  lds
    s_add_u32 m0, s67, 10240
    s_add_u32 s63, s58, 32768
    buffer_load_dwordx4 v28, s[44:47], s63 offen  lds
    s_add_u32 m0, s67, 11264
    s_add_u32 s63, s58, 163840
    buffer_load_dwordx4 v41, s[44:47], s63 offen  lds
    s_add_u32 m0, s67, 12288
    s_add_u32 s63, s58, 262144
    buffer_load_dwordx4 v28, s[44:47], s63 offen  lds
    s_add_u32 m0, s67, 13312
    s_add_u32 s63, s58, 393216
    buffer_load_dwordx4 v41, s[44:47], s63 offen  lds
    s_add_u32 m0, s67, 14336
    s_add_u32 s63, s58, 294912
    buffer_load_dwordx4 v28, s[44:47], s63 offen  lds
    s_add_u32 m0, s67, 15360
    s_add_u32 s63, s58, 425984
    buffer_load_dwordx4 v41, s[44:47], s63 offen  lds
    s_waitcnt lgkmcnt(0)
    ds_read_b64_tr_b16 v[240:241], v36 offset:24576
    ds_read_b64_tr_b16 v[242:243], v36 offset:25088
    ds_read_b64_tr_b16 v[244:245], v36 offset:26624
    ds_read_b64_tr_b16 v[246:247], v36 offset:27136
    ds_read_b64_tr_b16 v[248:249], v37 offset:24576
    ds_read_b64_tr_b16 v[250:251], v37 offset:25088
    ds_read_b64_tr_b16 v[252:253], v37 offset:26624
    ds_read_b64_tr_b16 v[254:255], v37 offset:27136
    s_waitcnt lgkmcnt(4)
    ds_read_b64_tr_b16 v[88:89], v38 offset:24576
    ds_read_b64_tr_b16 v[90:91], v38 offset:25088
    ds_read_b64_tr_b16 v[92:93], v38 offset:26624
    ds_read_b64_tr_b16 v[94:95], v38 offset:27136
    ds_read_b64_tr_b16 v[96:97], v39 offset:24576
    ds_read_b64_tr_b16 v[98:99], v39 offset:25088
    ds_read_b64_tr_b16 v[100:101], v39 offset:26624
    ds_read_b64_tr_b16 v[102:103], v39 offset:27136
    s_waitcnt vmcnt(8) lgkmcnt(0)
    s_barrier
    s_mov_b32 s44, s26
    s_and_b32 s45, s27, 0xffff
    s_xor_b32 s58, s56, 0
    s_lshl_b32 s58, s58, 15
    s_add_u32 s58, s58, s4
    s_add_u32 m0, s67, 16384
    s_add_u32 s63, s58, 0
    buffer_load_dwordx4 v29, s[44:47], s63 offen  lds
    s_add_u32 m0, s67, 17408
    s_add_u32 s63, s58, 4096
    buffer_load_dwordx4 v29, s[44:47], s63 offen  lds
    s_add_u32 m0, s67, 18432
    s_add_u32 s63, s58, 8192
    buffer_load_dwordx4 v29, s[44:47], s63 offen  lds
    s_add_u32 m0, s67, 19456
    s_add_u32 s63, s58, 12288
    buffer_load_dwordx4 v29, s[44:47], s63 offen  lds
    s_add_u32 m0, s67, 20480
    s_add_u32 s63, s58, 16384
    buffer_load_dwordx4 v40, s[44:47], s63 offen  lds
    s_lshl_b32 s63, s57, 14
    s_lshl_b32 s64, s56, 12
    s_add_u32 s82, s63, s64
    s_lshr_b32 s83, s82, 2
    s_add_u32 s83, s83, 33554432
    s_mov_b32 s69, 0
    s_add_u32 s8, s36, s71
    s_addc_u32 s9, s37, 0
    s_add_u32 s10, s36, s72
    s_addc_u32 s11, s37, 0
    s_add_u32 s12, s36, s73
    s_addc_u32 s13, s37, 0
    s_add_u32 s14, s36, s74
    s_addc_u32 s15, s37, 0
    s_add_u32 s16, s36, s75
    s_addc_u32 s17, s37, 0
    s_add_u32 s18, s36, s76
    s_addc_u32 s19, s37, 0
    s_add_u32 s20, s36, s77
    s_addc_u32 s21, s37, 0
    s_add_u32 s22, s36, s78
    s_addc_u32 s23, s37, 0
    s_add_u32 s24, s36, s79
    s_addc_u32 s25, s37, 0
    s_add_u32 s34, s36, s80
    s_addc_u32 s35, s37, 0
    s_add_u32 s26, s36, s81
    s_addc_u32 s27, s37, 0
    s_add_u32 s28, s36, s82
    s_addc_u32 s29, s37, 0
    s_add_u32 s30, s36, s83
    s_addc_u32 s31, s37, 0
    s_add_u32 s32, s36, s3
    s_addc_u32 s33, s37, 0
    s_add_u32 s48, s36, s85
    s_addc_u32 s49, s37, 0
    s_cmp_eq_u32 s56, 0
    s_cselect_b32 s50, 128, 0
    s_lshl_b32 s64, s57, 7
    s_add_u32 s64, s64, 64028672
    s_add_u32 s52, s36, s64
    s_addc_u32 s53, s37, 0
    s_cmp_eq_u32 s56, 3
    s_cselect_b32 s54, 24, 0
    s_mov_b32 s55, 0x20000
    s_mov_b32 s82, 0x3f803f80
    s_mov_b32 s83, 0x3f803f80
    s_mov_b32 s63, s84
    s_mov_b32 s84, 0x00010001
    s_mov_b32 s85, 0x00010001
    s_mov_b32 s81, s63
    s_mov_b32 s79, 0xd4800000
    s_mov_b32 s80, 0x28000000
    v_mov_b64 v[104:105], 0
    v_mov_b64 v[106:107], 0
    v_mov_b64 v[108:109], 0
    v_mov_b64 v[110:111], 0
    v_mov_b64 v[112:113], 0
    v_mov_b64 v[114:115], 0
    v_mov_b64 v[116:117], 0
    v_mov_b64 v[118:119], 0
    v_mov_b64 v[120:121], 0
    v_mov_b64 v[122:123], 0
    v_mov_b64 v[124:125], 0
    v_mov_b64 v[126:127], 0
    s_add_u32 m0, s67, 21504
    s_add_u32 s63, s58, 20480
    buffer_load_dwordx4 v40, s[44:47], s63 offen  lds
    s_add_u32 m0, s67, 22528
    s_add_u32 s63, s58, 24576
    buffer_load_dwordx4 v40, s[44:47], s63 offen  lds
    s_add_u32 m0, s67, 23552
    s_add_u32 s63, s58, 28672
    buffer_load_dwordx4 v40, s[44:47], s63 offen  lds
    ds_write_b128 v11, v[88:91] offset:32768
    ds_write_b128 v11, v[92:95] offset:33792
    ds_write_b128 v11, v[96:99] offset:34816
    ds_write_b128 v11, v[100:103] offset:35840
    s_waitcnt lgkmcnt(0)
    ds_read_b64_tr_b16 v[72:73], v30 offset:0
    ds_read_b64_tr_b16 v[74:75], v30 offset:2048
    ds_read_b64_tr_b16 v[76:77], v30 offset:4096
    ds_read_b64_tr_b16 v[78:79], v30 offset:6144
    ds_read_b64_tr_b16 v[80:81], v42 offset:0
    ds_read_b64_tr_b16 v[82:83], v42 offset:2048
    ds_read_b64_tr_b16 v[84:85], v42 offset:4096
    ds_read_b64_tr_b16 v[86:87], v42 offset:6144
    s_waitcnt lgkmcnt(4)
    ds_read_b64_tr_b16 v[88:89], v31 offset:0
    ds_read_b64_tr_b16 v[90:91], v31 offset:2048
    ds_read_b64_tr_b16 v[92:93], v31 offset:4096
    ds_read_b64_tr_b16 v[94:95], v31 offset:6144
    ds_read_b64_tr_b16 v[96:97], v43 offset:0
    ds_read_b64_tr_b16 v[98:99], v43 offset:2048
    ds_read_b64_tr_b16 v[100:101], v43 offset:4096
    ds_read_b64_tr_b16 v[102:103], v43 offset:6144
    s_waitcnt vmcnt(8) lgkmcnt(0)
    s_barrier
    s_xor_b32 s58, s56, 3
    s_lshl_b32 s58, s58, 15
    s_add_u32 s58, s58, s4
    s_add_u32 m0, s67, 24576
    s_add_u32 s63, s58, 0
    buffer_load_dwordx4 v29, s[44:47], s63 offen  lds
    s_add_u32 m0, s67, 25600
    s_add_u32 s63, s58, 4096
    buffer_load_dwordx4 v29, s[44:47], s63 offen  lds
    s_add_u32 m0, s67, 26624
    s_add_u32 s63, s58, 8192
    buffer_load_dwordx4 v29, s[44:47], s63 offen  lds
    s_add_u32 m0, s67, 27648
    s_add_u32 s63, s58, 12288
    buffer_load_dwordx4 v29, s[44:47], s63 offen  lds
    s_add_u32 m0, s67, 28672
    s_add_u32 s63, s58, 16384
    buffer_load_dwordx4 v40, s[44:47], s63 offen  lds
    s_add_u32 m0, s67, 29696
    s_add_u32 s63, s58, 20480
    buffer_load_dwordx4 v40, s[44:47], s63 offen  lds
    s_add_u32 m0, s67, 30720
    s_add_u32 s63, s58, 24576
    buffer_load_dwordx4 v40, s[44:47], s63 offen  lds
    s_add_u32 m0, s67, 31744
    s_add_u32 s63, s58, 28672
    buffer_load_dwordx4 v40, s[44:47], s63 offen  lds
    ds_write_b128 v11, v[72:75] offset:0
    ds_write_b128 v11, v[76:79] offset:1024
    ds_write_b128 v11, v[80:83] offset:2048
    ds_write_b128 v11, v[84:87] offset:3072
    ds_write_b128 v11, v[88:91] offset:4096
    ds_write_b128 v11, v[92:95] offset:5120
    ds_write_b128 v11, v[96:99] offset:6144
    ds_write_b128 v11, v[100:103] offset:7168
    v_min_u32 v58, 4, v13
    s_lshl_b32 s66, s57, 7
    s_add_u32 s66, s66, 64028672
    buffer_load_dword v59, v58, s[36:39], s66 offen sc1
    s_waitcnt lgkmcnt(0)
    ds_read_b64_tr_b16 v[72:73], v30 offset:8192
    ds_read_b64_tr_b16 v[74:75], v30 offset:10240
    ds_read_b64_tr_b16 v[76:77], v30 offset:12288
    ds_read_b64_tr_b16 v[78:79], v30 offset:14336
    ds_read_b64_tr_b16 v[80:81], v42 offset:8192
    ds_read_b64_tr_b16 v[82:83], v42 offset:10240
    ds_read_b64_tr_b16 v[84:85], v42 offset:12288
    ds_read_b64_tr_b16 v[86:87], v42 offset:14336
    s_waitcnt lgkmcnt(4)
    ds_read_b64_tr_b16 v[88:89], v31 offset:8192
    ds_read_b64_tr_b16 v[90:91], v31 offset:10240
    ds_read_b64_tr_b16 v[92:93], v31 offset:12288
    ds_read_b64_tr_b16 v[94:95], v31 offset:14336
    ds_read_b64_tr_b16 v[96:97], v43 offset:8192
    ds_read_b64_tr_b16 v[98:99], v43 offset:10240
    ds_read_b64_tr_b16 v[100:101], v43 offset:12288
    ds_read_b64_tr_b16 v[102:103], v43 offset:14336
    s_waitcnt vmcnt(8) lgkmcnt(0)
    s_barrier
    ds_write_b128 v11, v[72:75] offset:8192
    ds_write_b128 v11, v[76:79] offset:9216
    ds_write_b128 v11, v[80:83] offset:10240
    ds_write_b128 v11, v[84:87] offset:11264
    ds_write_b128 v11, v[88:91] offset:12288
    ds_write_b128 v11, v[92:95] offset:13312
    ds_write_b128 v11, v[96:99] offset:14336
    ds_write_b128 v11, v[100:103] offset:15360
    s_waitcnt lgkmcnt(0)
    ds_read_b64_tr_b16 v[72:73], v36 offset:16384
    ds_read_b64_tr_b16 v[74:75], v36 offset:16896
    ds_read_b64_tr_b16 v[76:77], v36 offset:18432
    ds_read_b64_tr_b16 v[78:79], v36 offset:18944
    ds_read_b64_tr_b16 v[80:81], v37 offset:16384
    ds_read_b64_tr_b16 v[82:83], v37 offset:16896
    ds_read_b64_tr_b16 v[84:85], v37 offset:18432
    ds_read_b64_tr_b16 v[86:87], v37 offset:18944
    s_waitcnt lgkmcnt(4)
    ds_read_b64_tr_b16 v[88:89], v38 offset:16384
    ds_read_b64_tr_b16 v[90:91], v38 offset:16896
    ds_read_b64_tr_b16 v[92:93], v38 offset:18432
    ds_read_b64_tr_b16 v[94:95], v38 offset:18944
    ds_read_b64_tr_b16 v[96:97], v39 offset:16384
    ds_read_b64_tr_b16 v[98:99], v39 offset:16896
    ds_read_b64_tr_b16 v[100:101], v39 offset:18432
    ds_read_b64_tr_b16 v[102:103], v39 offset:18944
    s_waitcnt vmcnt(0) lgkmcnt(0)
    s_barrier
    ds_write_b128 v11, v[72:75] offset:16384
    ds_write_b128 v11, v[76:79] offset:17408
    ds_write_b128 v11, v[80:83] offset:18432
    ds_write_b128 v11, v[84:87] offset:19456
    ds_write_b128 v11, v[88:91] offset:20480
    ds_write_b128 v11, v[92:95] offset:21504
    ds_write_b128 v11, v[96:99] offset:22528
    ds_write_b128 v11, v[100:103] offset:23552
    v_cmp_gt_u32 vcc, 1, v59
    s_cbranch_vccz L_KV0_OK
L_poll_6:
    buffer_load_dword v59, v58, s[36:39], s66 offen sc1
    s_sub_u32 s61, s61, 1
    s_cbranch_scc1 L_END
    s_waitcnt vmcnt(0)
    v_cmp_gt_u32 vcc, 1, v59
    s_cbranch_vccnz L_poll_6
L_polld_7:
L_KV0_OK:
    global_load_dwordx4 v[128:131], v0, s[28:29] offset:0 sc1
    global_load_dwordx4 v[132:135], v0, s[28:29] offset:1024 sc1
    global_load_dwordx4 v[136:139], v0, s[28:29] offset:2048 sc1
    global_load_dwordx4 v[140:143], v0, s[28:29] offset:3072 sc1
    s_waitcnt lgkmcnt(0)
    ds_read_b64_tr_b16 v[72:73], v36 offset:24576
    ds_read_b64_tr_b16 v[74:75], v36 offset:25088
    ds_read_b64_tr_b16 v[76:77], v36 offset:26624
    ds_read_b64_tr_b16 v[78:79], v36 offset:27136
    ds_read_b64_tr_b16 v[80:81], v37 offset:24576
    ds_read_b64_tr_b16 v[82:83], v37 offset:25088
    ds_read_b64_tr_b16 v[84:85], v37 offset:26624
    ds_read_b64_tr_b16 v[86:87], v37 offset:27136
    s_waitcnt lgkmcnt(4)
    ds_read_b64_tr_b16 v[88:89], v38 offset:24576
    ds_read_b64_tr_b16 v[90:91], v38 offset:25088
    ds_read_b64_tr_b16 v[92:93], v38 offset:26624
    ds_read_b64_tr_b16 v[94:95], v38 offset:27136
    ds_read_b64_tr_b16 v[96:97], v39 offset:24576
    ds_read_b64_tr_b16 v[98:99], v39 offset:25088
    ds_read_b64_tr_b16 v[100:101], v39 offset:26624
    ds_read_b64_tr_b16 v[102:103], v39 offset:27136
    s_waitcnt lgkmcnt(0)
    ds_write_b128 v11, v[72:75] offset:24576
    ds_write_b128 v11, v[76:79] offset:25600
    ds_write_b128 v11, v[80:83] offset:26624
    ds_write_b128 v11, v[84:87] offset:27648
    ds_write_b128 v11, v[88:91] offset:28672
    ds_write_b128 v11, v[92:95] offset:29696
    ds_write_b128 v11, v[96:99] offset:30720
    ds_write_b128 v11, v[100:103] offset:31744
    ds_read_b128 v[24:27], v11 offset:0
    ds_read_b128 v[28:31], v11 offset:1024
    ds_read_b128 v[32:35], v11 offset:2048
    ds_read_b128 v[36:39], v11 offset:3072
    ds_read_b128 v[40:43], v11 offset:8192
    ds_read_b128 v[44:47], v11 offset:9216
    ds_read_b128 v[48:51], v11 offset:10240
    ds_read_b128 v[52:55], v11 offset:11264
    s_cmp_eq_u32 s69, 62
    s_cselect_b32 s4, 0, 524288
    s_add_u32 s28, s28, s4
    s_addc_u32 s29, s29, 0
    v_mov_b32 v23, s69
    s_add_u32 s44, s36, s7
    s_addc_u32 s45, s37, 0
    s_cmp_eq_u32 s56, 1
    s_cselect_b32 s46, 4, 0
    s_waitcnt lgkmcnt(8)
    v_mov_b64 v[72:73], v[64:65]
    v_mov_b64 v[74:75], v[66:67]
    v_mov_b64 v[76:77], v[68:69]
    v_mov_b64 v[78:79], v[70:71]
    ds_write_b128 v2, v[76:79] offset:1024
    s_lshl_b32 s63, s56, 11
    s_add_u32 m0, s63, 148480
    v_lshlrev_b32 v80, 4, v13
    v_and_b32 v81, 0x800, v80
    v_mul_u32_u24 v81, 127, v81
    v_add_u32 v81, v81, v80
    s_xor_b32 s26, s26, 0x40000
    global_load_dword v19, v81, s[26:27] sc1
    s_xor_b32 s26, s26, 0x40000
    v_and_b32 v82, 0x100, v80
    v_and_b32 v80, 0xc0, v80
    v_lshl_or_b32 v80, v82, 5, v80
    global_load_dword v19, v80, s[14:15] sc1
    global_load_dwordx4 v[56:59], v0, s[28:29] offset:0 sc1
    s_cmp_eq_u32 s96, 0
    s_cbranch_scc0 L_ENT_S
    s_branch L_ENT_F
.p2align 6
L_GO_F:
    s_nop 15
    s_nop 7
L_LOOP_F:
    s_barrier
    global_load_dwordx4 v[72:75], v1, s[8:9] sc1
    s_nop 11
    global_load_lds_dwordx4 v1, s[10:11] sc1
    s_cmp_eq_u32 s69, 63
    s_cbranch_scc1 L_LAST
    s_nop 15
    s_nop 0
L_ENT0_F:
    buffer_store_dword v23, v13, s[44:47], 0 offen sc1
    global_store_dwordx4 v0, v[100:103], s[30:31] sc1
    global_load_dwordx4 v[56:59], v0, s[28:29] offset:0 sc1
L_ENT_F:
    s_waitcnt vmcnt(4) lgkmcnt(0)
    ds_write_b128 v2, v[72:75]
    v_smfmac_f32_16x16x64_bf16 v[104:107], v[72:75], a[0:7], v15
    v_smfmac_f32_16x16x64_bf16 v[112:115], v[72:75], a[8:15], v15
    v_smfmac_f32_16x16x64_bf16 v[120:123], v[72:75], v[24:31], v15
    s_waitcnt vmcnt(3) lgkmcnt(0)
    s_barrier
    ds_read_b128 v[76:79], v2 offset:1024
    ds_read_b128 v[80:83], v3 offset:0
    v_smfmac_f32_16x16x64_bf16 v[124:127], v[72:75], v[32:39], v15
    ds_read_b128 v[84:87], v3 offset:1024
    global_load_dwordx4 v[60:63], v0, s[28:29] offset:1024 sc1
    v_smfmac_f32_16x16x64_bf16 v[108:111], v[72:75], a[128:135], v15
    ds_read_b128 v[88:91], v4 offset:0
    v_smfmac_f32_16x16x64_bf16 v[116:119], v[72:75], a[136:143], v15
    ds_read_b128 v[92:95], v4 offset:1024
    buffer_load_dword v19, v13, s[52:55], 0 offen sc1
    s_waitcnt lgkmcnt(4)
    v_smfmac_f32_16x16x64_bf16 v[104:107], v[76:79], a[16:23], v15
    ds_read_b128 v[96:99], v5 offset:0
    v_smfmac_f32_16x16x64_bf16 v[112:115], v[76:79], a[24:31], v15
    ds_read_b128 v[100:103], v5 offset:1024
    global_load_dwordx4 v[64:67], v0, s[28:29] offset:2048 sc1
    s_waitcnt lgkmcnt(4)
    v_smfmac_f32_16x16x64_bf16 v[104:107], v[80:83], a[32:39], v15
    ds_read_b128 v[24:27], v11 offset:4096
    v_smfmac_f32_16x16x64_bf16 v[112:115], v[80:83], a[40:47], v15
    ds_read_b128 v[28:31], v11 offset:5120
    v_smfmac_f32_16x16x64_bf16 v[104:107], v[84:87], a[48:55], v15
    ds_read_b128 v[32:35], v11 offset:6144
    v_smfmac_f32_16x16x64_bf16 v[112:115], v[84:87], a[56:63], v15
    ds_read_b128 v[36:39], v11 offset:7168
    global_load_dwordx4 v[68:71], v0, s[28:29] offset:3072 sc1
    s_waitcnt lgkmcnt(4)
    v_smfmac_f32_16x16x64_bf16 v[104:107], v[88:91], a[64:71], v15
    v_smfmac_f32_16x16x64_bf16 v[104:107], v[92:95], a[80:87], v15
    v_smfmac_f32_16x16x64_bf16 v[104:107], v[96:99], a[96:103], v15
    v_smfmac_f32_16x16x64_bf16 v[104:107], v[100:103], a[112:119], v15
    global_store_dword v13, v9, s[26:27] offset:768
    v_smfmac_f32_16x16x64_bf16 v[112:115], v[88:91], a[72:79], v15
    global_store_dword v13, v9, s[26:27] offset:1024
    v_smfmac_f32_16x16x64_bf16 v[112:115], v[92:95], a[88:95], v15
    v_add_f32 v104, v104, v106
    v_smfmac_f32_16x16x64_bf16 v[112:115], v[96:99], a[104:111], v15
    v_add_f32 v105, v105, v107
    v_smfmac_f32_16x16x64_bf16 v[112:115], v[100:103], a[120:127], v15
    v_cmp_u_f32 vcc, v104, v105
    v_smfmac_f32_16x16x64_bf16 v[120:123], v[76:79], v[40:47], v15
    s_cbranch_vccnz L_BFAIL_F
L_BOK_F:
    v_cvt_pk_bf16_f32 v73, v104, v105
    v_smfmac_f32_16x16x64_bf16 v[124:127], v[76:79], v[48:55], v15
    ds_read_b128 v[40:43], v11 offset:12288
    v_add_f32 v112, v112, v114
    v_add_f32 v113, v113, v115
    v_cvt_pk_bf16_f32 v75, v112, v113
    v_mfma_f32_16x16x16_bf16 v[104:107], v[72:73], v[16:17], 0
    ds_read_b128 v[44:47], v11 offset:13312
    s_add_u32 s69, s69, 1
    v_mfma_f32_16x16x16_bf16 v[112:115], v[74:75], v[16:17], 0
    ds_read_b128 v[48:51], v11 offset:14336
    v_mov_b32 v18, s69
    v_smfmac_f32_16x16x64_bf16 v[108:111], v[76:79], a[144:151], v15
    ds_read_b128 v[52:55], v11 offset:15360
    v_cvt_pk_bf16_f32 v104, v104, v105
    v_cvt_pk_bf16_f32 v105, v106, v107
    v_cvt_pk_bf16_f32 v106, v112, v113
    v_cvt_pk_bf16_f32 v107, v114, v115
    v_smfmac_f32_16x16x64_bf16 v[108:111], v[80:83], a[160:167], v15
    global_store_dword v13, v9, s[26:27] offset:1280
    v_mfma_f32_16x16x32_bf16 v[112:115], v[104:107], v[128:131], 0
    global_store_dword v13, v9, s[26:27] offset:1536
    v_mfma_f32_16x16x32_bf16 v[128:131], v[104:107], v[132:135], 0
    global_store_dword v13, v9, s[26:27] offset:1792
    v_smfmac_f32_16x16x64_bf16 v[108:111], v[84:87], a[176:183], v15
    ds_write2_b32 v6, v114, v115 offset0:0 offset1:4
    v_smfmac_f32_16x16x64_bf16 v[108:111], v[88:91], a[192:199], v15
    ds_write2_b32 v14, v130, v131 offset0:0 offset1:4
    v_smfmac_f32_16x16x64_bf16 v[108:111], v[92:95], a[208:215], v15
    global_store_dword v13, v9, s[26:27] offset:0
    v_smfmac_f32_16x16x64_bf16 v[108:111], v[96:99], a[224:231], v15
    global_store_dword v13, v9, s[26:27] offset:256
    v_smfmac_f32_16x16x64_bf16 v[108:111], v[100:103], a[240:247], v15
    global_store_dword v13, v9, s[26:27] offset:512
    v_smfmac_f32_16x16x64_bf16 v[116:119], v[76:79], a[152:159], v15
    v_smfmac_f32_16x16x64_bf16 v[116:119], v[80:83], a[168:175], v15
    s_waitcnt lgkmcnt(0)
    s_barrier
    v_smfmac_f32_16x16x64_bf16 v[116:119], v[84:87], a[184:191], v15
    ds_read_b128 v[128:131], v10 offset:8192
    v_add_f32 v108, v108, v110
    v_smfmac_f32_16x16x64_bf16 v[116:119], v[88:91], a[200:207], v15
    ds_read_b128 v[132:135], v10 offset:9216
    v_add_f32 v109, v109, v111
    v_smfmac_f32_16x16x64_bf16 v[116:119], v[92:95], a[216:223], v15
    ds_read_b128 v[104:107], v10 offset:10240
    v_cvt_pk_bf16_f32 v72, v108, v109
    v_smfmac_f32_16x16x64_bf16 v[116:119], v[96:99], a[232:239], v15
    ds_read_b128 v[112:115], v10 offset:11264
    v_smfmac_f32_16x16x64_bf16 v[116:119], v[100:103], a[248:255], v15
    v_smfmac_f32_16x16x64_bf16 v[120:123], v[80:83], v[24:31], v15
    s_waitcnt lgkmcnt(2)
    v_add_f32 v128, v128, v132
    v_mfma_f32_16x16x16_bf16 v[108:111], v[72:73], v[16:17], 0
    v_add_f32 v116, v116, v118
    v_add_f32 v117, v117, v119
    v_cvt_pk_bf16_f32 v74, v116, v117
    v_add_f32 v129, v129, v133
    v_add_f32 v130, v130, v134
    v_mfma_f32_16x16x16_bf16 v[116:119], v[74:75], v[16:17], 0
    s_waitcnt lgkmcnt(0)
    v_cvt_pk_bf16_f32 v76, v108, v109
    v_cvt_pk_bf16_f32 v77, v110, v111
    v_add_f32 v131, v131, v135
    v_add_f32 v104, v104, v112
    v_smfmac_f32_16x16x64_bf16 v[124:127], v[80:83], v[32:39], v15
    ds_read_b128 v[24:27], v11 offset:16384
    v_cvt_pk_bf16_f32 v78, v116, v117
    v_cvt_pk_bf16_f32 v79, v118, v119
    v_add_f32 v105, v105, v113
    v_add_f32 v128, v128, v104
    v_mfma_f32_16x16x32_bf16 v[108:111], v[76:79], v[76:79], 0
    v_add_f32 v129, v129, v105
    v_add_f32 v106, v106, v114
    v_smfmac_f32_16x16x64_bf16 v[120:123], v[84:87], v[40:47], v15
    ds_read_b128 v[28:31], v11 offset:17408
    v_add_f32 v107, v107, v115
    v_smfmac_f32_16x16x64_bf16 v[124:127], v[84:87], v[48:55], v15
    ds_write2_b32 v7, v108, v109 offset0:0 offset1:8
    v_smfmac_f32_16x16x64_bf16 v[120:123], v[88:91], v[144:151], v15
    v_exp_f32 v128, v128
    v_add_f32 v130, v130, v106
    v_smfmac_f32_16x16x64_bf16 v[124:127], v[88:91], v[152:159], v15
    v_exp_f32 v129, v129
    v_add_f32 v131, v131, v107
    v_smfmac_f32_16x16x64_bf16 v[120:123], v[92:95], v[160:167], v15
    v_exp_f32 v130, v130
    v_smfmac_f32_16x16x64_bf16 v[124:127], v[92:95], v[168:175], v15
    s_waitcnt lgkmcnt(0)
    s_barrier
    v_smfmac_f32_16x16x64_bf16 v[120:123], v[96:99], v[176:183], v15
    ds_read_b128 v[116:119], v8 offset:12288
    v_exp_f32 v131, v131
    v_cvt_pk_bf16_f32 v132, v128, v129
    v_smfmac_f32_16x16x64_bf16 v[120:123], v[100:103], v[192:199], v15
    ds_read_b128 v[32:35], v11 offset:18432
    v_cvt_pk_bf16_f32 v133, v130, v131
    v_mov_b32_dpp v104, v132 quad_perm:[0,1,0,1] row_mask:0xf bank_mask:0xf
    v_smfmac_f32_16x16x64_bf16 v[124:127], v[96:99], v[184:191], v15
    ds_read_b128 v[36:39], v11 offset:19456
    v_mov_b32_dpp v106, v132 quad_perm:[2,3,2,3] row_mask:0xf bank_mask:0xf
    v_mov_b32_dpp v105, v133 quad_perm:[0,1,0,1] row_mask:0xf bank_mask:0xf
    v_smfmac_f32_16x16x64_bf16 v[124:127], v[100:103], v[200:207], v15
    ds_read_b128 v[40:43], v11 offset:20480
    s_waitcnt lgkmcnt(3)
    v_mov_b32_dpp v107, v133 quad_perm:[2,3,2,3] row_mask:0xf bank_mask:0xf
    v_add_f32 v116, v116, v117
    v_add_f32 v118, v118, v119
    v_mfma_f32_16x16x32_bf16 v[128:131], v[136:139], v[104:107], 0
    v_add_f32 v116, v116, v118
    v_mul_f32 v116, s81, v116
    v_mfma_f32_16x16x32_bf16 v[132:135], v[140:143], v[104:107], 0
    v_exp_f32 v116, v116
    v_mov_b64 v[112:113], s[82:83]
    v_mov_b64 v[114:115], s[82:83]
    v_mov_b32_dpp v118, v116 quad_perm:[0,1,0,1] row_mask:0xf bank_mask:0xf
    v_mov_b32_dpp v119, v116 quad_perm:[2,3,2,3] row_mask:0xf bank_mask:0xf
    v_mfma_f32_16x16x32_bf16 v[72:75], v[112:115], v[104:107], 0
    v_cvt_pk_bf16_f32 v20, v118, v119
    v_add_f32 v120, v120, v122
    v_add_f32 v121, v121, v123
    v_add_f32 v124, v124, v126
    v_add_f32 v125, v125, v127
    v_cvt_pk_bf16_f32 v120, v120, v121
    v_cvt_pk_bf16_f32 v121, v124, v125
    v_mfma_f32_16x16x16_bf16 v[72:75], v[112:113], v[20:21], v[72:75]
    ds_read_b128 v[44:47], v11 offset:21504
    v_cvt_pk_bf16_f32 v23, v118, v119
    v_mfma_f32_16x16x16_bf16 v[128:131], v[120:121], v[20:21], v[128:131]
    global_store_dword v21, v18, s[32:33]
    ds_read_b128 v[48:51], v11 offset:22528
    ds_read_b128 v[52:55], v11 offset:23552
    v_mfma_f32_16x16x16_bf16 v[132:135], v[120:121], v[22:23], v[132:135]
    v_add_u32 v18, s79, v72
    v_rcp_f32 v74, v72
    v_cmp_le_u32 vcc, s80, v18
L_MAXED2_F:
    v_mul_f32 v128, v74, v128
    v_mul_f32 v129, v74, v129
    v_pk_mul_f32 v[130:131], v[130:131], v[74:75] op_sel_hi:[1,0]
    v_cvt_pk_bf16_f32 v108, v128, v129
    v_pk_mul_f32 v[132:133], v[132:133], v[74:75] op_sel_hi:[1,0]
    v_pk_mul_f32 v[134:135], v[134:135], v[74:75] op_sel_hi:[1,0]
    v_cvt_pk_bf16_f32 v109, v130, v131
    v_cvt_pk_bf16_f32 v110, v132, v133
    v_cvt_pk_bf16_f32 v111, v134, v135
    s_cbranch_vccnz L_MAX_F
    ds_write_b128 v2, v[108:111]
    v_mfma_f32_16x16x1_4b_f32 v[88:103], v21, v21, 0
    ds_read_b128 v[80:83], v11 offset:24576
    ds_read_b128 v[84:87], v11 offset:25600
    s_waitcnt lgkmcnt(3)
    v_smfmac_f32_16x16x64_bf16 v[88:91], v[108:111], v[24:31], v15
    s_waitcnt lgkmcnt(2)
    s_barrier
    ds_read_b128 v[128:131], v3
    v_smfmac_f32_16x16x64_bf16 v[92:95], v[108:111], v[32:39], v15
    ds_read_b128 v[132:135], v4
    ds_read_b128 v[112:115], v5
    v_smfmac_f32_16x16x64_bf16 v[96:99], v[108:111], v[40:47], v15
    ds_read_b128 v[136:139], v11 offset:26624
    v_smfmac_f32_16x16x64_bf16 v[100:103], v[108:111], v[48:55], v15
    ds_read_b128 v[140:143], v11 offset:27648
    s_waitcnt lgkmcnt(4)
    v_smfmac_f32_16x16x64_bf16 v[88:91], v[128:131], v[208:215], v15
    ds_read_b128 v[24:27], v11 offset:32768
    s_waitcnt lgkmcnt(4)
    v_smfmac_f32_16x16x64_bf16 v[88:91], v[132:135], v[240:247], v15
    ds_read_b128 v[28:31], v11 offset:33792
    s_waitcnt lgkmcnt(4)
    v_smfmac_f32_16x16x64_bf16 v[88:91], v[112:115], v[80:87], v15
    ds_read_b128 v[32:35], v11 offset:28672
    ds_read_b128 v[36:39], v11 offset:29696
    v_smfmac_f32_16x16x64_bf16 v[92:95], v[128:131], v[216:223], v15
    ds_read_b128 v[40:43], v11 offset:34816
    v_smfmac_f32_16x16x64_bf16 v[92:95], v[132:135], v[248:255], v15
    ds_read_b128 v[44:47], v11 offset:35840
    s_waitcnt lgkmcnt(6)
    v_cvt_pk_bf16_f32 v88, v88, v90
    v_smfmac_f32_16x16x64_bf16 v[92:95], v[112:115], v[136:143], v15
    global_store_dword v12, v88, s[16:17] offset:0
    v_cvt_pk_bf16_f32 v89, v89, v91
    v_smfmac_f32_16x16x64_bf16 v[96:99], v[128:131], v[224:231], v15
    global_store_dword v12, v89, s[16:17] offset:256
    ds_read_b128 v[48:51], v11 offset:30720
    s_waitcnt lgkmcnt(3)
    v_and_b32 v122, 0x380, v0
    v_smfmac_f32_16x16x64_bf16 v[96:99], v[132:135], v[24:31], v15
    ds_read_b128 v[52:55], v11 offset:31744
    buffer_load_dword v116, v13, s[48:51], 0 offen sc1
    v_cvt_pk_bf16_f32 v93, v93, v95
    v_smfmac_f32_16x16x64_bf16 v[96:99], v[112:115], v[32:39], v15
    global_store_dword v12, v93, s[18:19] offset:256
    v_cvt_pk_bf16_f32 v92, v92, v94
    v_smfmac_f32_16x16x64_bf16 v[100:103], v[128:131], v[232:239], v15
    global_store_dword v12, v92, s[18:19] offset:0
    s_waitcnt lgkmcnt(2)
    v_add_u32 v122, v122, v0
    v_smfmac_f32_16x16x64_bf16 v[100:103], v[132:135], v[40:47], v15
    s_cmp_lg_u32 s56, 0
    s_waitcnt lgkmcnt(0)
    v_cvt_pk_bf16_f32 v97, v97, v99
    v_smfmac_f32_16x16x64_bf16 v[100:103], v[112:115], v[48:55], v15
    global_store_dword v12, v97, s[20:21] offset:256
    v_cvt_pk_bf16_f32 v96, v96, v98
    global_store_dword v12, v96, s[20:21] offset:0
    v_mov_b64 v[112:113], v[76:77]
    v_mov_b64 v[114:115], v[78:79]
    v_mov_b32 v23, s69
    s_nop 0
    v_cvt_pk_bf16_f32 v100, v100, v102
    v_cvt_pk_bf16_f32 v101, v101, v103
    global_store_dword v12, v100, s[22:23] offset:0
    global_store_dword v12, v101, s[22:23] offset:256
    s_cbranch_scc1 L_OTH_F
    buffer_load_dword v117, v13, s[48:51], 0 offen sc1
    ds_read_b128 v[104:107], v8 offset:13312
    s_xor_b32 s16, s16, 0x40000
    s_xor_b32 s18, s18, 0x40000
    s_xor_b32 s20, s20, 0x40000
    s_xor_b32 s22, s22, 0x40000
    s_add_u32 s30, s30, 0x20000
    s_addc_u32 s31, s31, 0
    s_xor_b32 s8, s8, 0x2000
    s_xor_b32 s10, s10, 0x2000
    s_cmp_eq_u32 s69, 62
    buffer_load_dword v118, v13, s[48:51], 0 offen sc1
    s_cselect_b32 s4, 0, 524288
    s_add_u32 s28, s28, s4
    s_addc_u32 s29, s29, 0
    s_xor_b32 s26, s26, 0x40000
    ds_read_b128 v[24:27], v11 offset:0
    ds_read_b128 v[28:31], v11 offset:1024
    ds_read_b128 v[32:35], v11 offset:2048
    ds_read_b128 v[36:39], v11 offset:3072
    ds_read_b128 v[40:43], v11 offset:8192
    ds_read_b128 v[44:47], v11 offset:9216
    buffer_load_dword v119, v13, s[48:51], 0 offen sc1
    ds_read_b128 v[48:51], v11 offset:10240
    ds_read_b128 v[52:55], v11 offset:11264
    s_nop 7
    buffer_load_dword v124, v13, s[48:51], 0 offen sc1
    s_nop 7
    s_waitcnt vmcnt(10)
    v_cmp_gt_u32 vcc, s69, v116
    s_nop 0
    s_cmp_lg_u32 vcc_lo, 0
    s_cbranch_scc0 L_SOK_F
    buffer_load_dword v116, v13, s[48:51], 0 offen sc1
    s_nop 3
L_SP_F:
    s_waitcnt vmcnt(4)
    v_cmp_gt_u32 vcc, s69, v117
    s_nop 0
    s_cmp_lg_u32 vcc_lo, 0
    s_cbranch_scc0 L_SLATE_F
    buffer_load_dword v117, v13, s[48:51], 0 offen sc1
    s_nop 3
    s_waitcnt vmcnt(4)
    v_cmp_gt_u32 vcc, s69, v118
    s_nop 0
    s_cmp_lg_u32 vcc_lo, 0
    s_cbranch_scc0 L_SLATE_F
    buffer_load_dword v118, v13, s[48:51], 0 offen sc1
    s_nop 3
    s_waitcnt vmcnt(4)
    v_cmp_gt_u32 vcc, s69, v119
    s_nop 0
    s_cmp_lg_u32 vcc_lo, 0
    s_cbranch_scc0 L_SLATE_F
    buffer_load_dword v119, v13, s[48:51], 0 offen sc1
    s_nop 3
    s_waitcnt vmcnt(4)
    v_cmp_gt_u32 vcc, s69, v124
    s_nop 0
    s_cmp_lg_u32 vcc_lo, 0
    s_cbranch_scc0 L_SLATE_F
    buffer_load_dword v124, v13, s[48:51], 0 offen sc1
    s_nop 3
    s_waitcnt vmcnt(4)
    v_cmp_gt_u32 vcc, s69, v116
    s_nop 0
    s_cmp_lg_u32 vcc_lo, 0
    s_cbranch_scc0 L_SLATE_F
    buffer_load_dword v116, v13, s[48:51], 0 offen sc1
    s_sub_u32 s61, s61, 1
    s_cbranch_scc1 L_END
    s_branch L_SP_F
L_SLATE_F:
    s_nop 15
    s_nop 15
    s_nop 3
L_SOK_F:
    global_load_dwordx4 v[72:75], v122, s[24:25] offset:-4096 sc1
    global_load_dwordx4 v[76:79], v122, s[24:25] offset:-3968 sc1
    global_load_dwordx4 v[80:83], v122, s[24:25] offset:0 sc1
    global_load_dwordx4 v[84:87], v122, s[24:25] offset:128 sc1
    global_load_dwordx4 v[88:91], v122, s[34:35] offset:-4096 sc1
    global_load_dwordx4 v[92:95], v122, s[34:35] offset:-3968 sc1
    global_load_dwordx4 v[96:99], v122, s[34:35] offset:0 sc1
    global_load_dwordx4 v[100:103], v122, s[34:35] offset:128 sc1
    s_mov_b64 exec, s[84:85]
    global_store_dword v0, v23, s[32:33] offset:1024
    s_mov_b64 exec, -1
    v_mov_b64 v[128:129], v[56:57]
    v_mov_b64 v[130:131], v[58:59]
    v_mov_b64 v[132:133], v[60:61]
    v_mov_b64 v[134:135], v[62:63]
    v_mov_b64 v[136:137], v[64:65]
    v_mov_b64 v[138:139], v[66:67]
    v_mov_b64 v[140:141], v[68:69]
    v_mov_b64 v[142:143], v[70:71]
    s_barrier
    s_waitcnt lgkmcnt(8)
L_ARE_F:
    s_waitcnt vmcnt(8)
    v_mfma_f32_16x16x32_bf16 v[108:111], v[104:107], v[72:75], 0
    s_waitcnt vmcnt(7)
    v_mfma_f32_16x16x32_bf16 v[108:111], v[104:107], v[76:79], v[108:111]
    s_waitcnt vmcnt(6)
    v_mfma_f32_16x16x32_bf16 v[108:111], v[104:107], v[80:83], v[108:111]
    s_waitcnt vmcnt(5)
    v_mfma_f32_16x16x32_bf16 v[108:111], v[104:107], v[84:87], v[108:111]
    s_waitcnt vmcnt(4)
    v_mfma_f32_16x16x32_bf16 v[108:111], v[104:107], v[88:91], v[108:111]
    s_waitcnt vmcnt(3)
    v_mfma_f32_16x16x32_bf16 v[108:111], v[104:107], v[92:95], v[108:111]
    s_waitcnt vmcnt(2)
    v_mfma_f32_16x16x32_bf16 v[108:111], v[104:107], v[96:99], v[108:111]
    s_waitcnt vmcnt(1)
    v_mfma_f32_16x16x32_bf16 v[108:111], v[104:107], v[100:103], v[108:111]
    s_nop 6
    s_nop 0
    v_cmp_u_f32 vcc, v108, v108
    v_cvt_pk_bf16_f32 v124, v108, v109
    s_cbranch_vccnz L_AFAIL_F
L_AOK_F:
    global_store_dword v13, v124, s[12:13]
    global_store_dword v13, v9, s[14:15]
    s_xor_b32 s24, s24, 0x40000
    s_xor_b32 s34, s34, 0x40000
    s_mov_b64 vcc, s[0:1]
    v_cndmask_b32_dpp v100, v120, v112, vcc quad_perm:[0,1,0,1] row_mask:0xf bank_mask:0xf
    v_cndmask_b32_dpp v101, v121, v113, vcc quad_perm:[0,1,0,1] row_mask:0xf bank_mask:0xf
    v_cndmask_b32 v102, v120, v114, vcc
    v_cndmask_b32 v103, v121, v115, vcc
    v_mov_b64 v[104:105], 0
    v_mov_b64 v[106:107], 0
    v_mov_b64 v[108:109], 0
    v_mov_b64 v[110:111], 0
    v_mov_b64 v[112:113], 0
    v_mov_b64 v[114:115], 0
    v_mov_b64 v[116:117], 0
    v_mov_b64 v[118:119], 0
    v_mov_b64 v[120:121], 0
    v_mov_b64 v[122:123], 0
    v_mov_b64 v[124:125], 0
    v_mov_b64 v[126:127], 0
    v_mov_b64 v[80:81], -1
    v_mov_b64 v[82:83], -1
    s_xor_b32 s12, s12, 0x2000
    s_xor_b32 s14, s14, 0x2000
    s_branch L_LOOP_F
.p2align 6
L_OTH_F:
    s_mov_b64 vcc, s[0:1]
    v_cndmask_b32_dpp v100, v120, v112, vcc quad_perm:[0,1,0,1] row_mask:0xf bank_mask:0xf
    v_cndmask_b32_dpp v101, v121, v113, vcc quad_perm:[0,1,0,1] row_mask:0xf bank_mask:0xf
    v_cndmask_b32 v102, v120, v114, vcc
    v_cndmask_b32 v103, v121, v115, vcc
    v_mov_b64 v[104:105], 0
    v_mov_b64 v[106:107], 0
    v_mov_b64 v[108:109], 0
    v_mov_b64 v[110:111], 0
    v_mov_b64 v[112:113], 0
    v_mov_b64 v[114:115], 0
    v_mov_b64 v[116:117], 0
    v_mov_b64 v[118:119], 0
    v_mov_b64 v[120:121], 0
    v_mov_b64 v[122:123], 0
    v_mov_b64 v[124:125], 0
    v_mov_b64 v[126:127], 0
    s_cmp_eq_u32 s69, 62
    s_cselect_b32 s4, 0, 524288
    s_add_u32 s28, s28, s4
    s_addc_u32 s29, s29, 0
    v_mov_b32 v23, s69
    s_waitcnt vmcnt(9)
    v_mov_b64 v[128:129], v[56:57]
    v_mov_b64 v[130:131], v[58:59]
    v_mov_b64 v[132:133], v[60:61]
    v_mov_b64 v[134:135], v[62:63]
    v_mov_b64 v[136:137], v[64:65]
    v_mov_b64 v[138:139], v[66:67]
    v_mov_b64 v[140:141], v[68:69]
    v_mov_b64 v[142:143], v[70:71]
    ds_read_b128 v[24:27], v11 offset:0
    ds_read_b128 v[28:31], v11 offset:1024
    ds_read_b128 v[32:35], v11 offset:2048
    ds_read_b128 v[36:39], v11 offset:3072
    ds_read_b128 v[40:43], v11 offset:8192
    ds_read_b128 v[44:47], v11 offset:9216
    ds_read_b128 v[48:51], v11 offset:10240
    ds_read_b128 v[52:55], v11 offset:11264
    s_xor_b32 s16, s16, 0x40000
    s_xor_b32 s18, s18, 0x40000
    s_xor_b32 s20, s20, 0x40000
    s_xor_b32 s22, s22, 0x40000
    s_add_u32 s30, s30, 0x20000
    s_addc_u32 s31, s31, 0
    s_xor_b32 s8, s8, 0x2000
    s_xor_b32 s10, s10, 0x2000
    v_mov_b64 v[80:81], -1
    v_mov_b64 v[82:83], -1
    s_cmp_eq_u32 s56, 3
    s_cbranch_scc1 L_NORS_F
    s_xor_b32 s26, s26, 0x40000
    s_waitcnt vmcnt(0)
    s_barrier
    s_cmp_lg_u32 s56, 2
    s_cbranch_scc1 L_LOOP_F
    v_mov_b32 v84, 0
    v_and_b32 v85, 127, v13
    s_branch L_GP_F
.p2align 6
L_GP_F:
    s_sub_u32 s61, s61, 1
    s_cbranch_scc1 L_END
    global_load_dword v84, v85, s[48:49] offset:1024 sc1
    s_waitcnt vmcnt(15)
    v_cmp_gt_u32 vcc, s69, v84
    s_cbranch_vccz L_GO_F
    global_load_dword v84, v85, s[48:49] offset:1024 sc1
    s_waitcnt vmcnt(15)
    v_cmp_gt_u32 vcc, s69, v84
    s_cbranch_vccz L_GO_F
    global_load_dword v84, v85, s[48:49] offset:1024 sc1
    s_waitcnt vmcnt(15)
    v_cmp_gt_u32 vcc, s69, v84
    s_cbranch_vccz L_GO_F
    global_load_dword v84, v85, s[48:49] offset:1024 sc1
    s_waitcnt vmcnt(15)
    v_cmp_gt_u32 vcc, s69, v84
    s_cbranch_vccz L_GO_F
    global_load_dword v84, v85, s[48:49] offset:1024 sc1
    s_waitcnt vmcnt(15)
    v_cmp_gt_u32 vcc, s69, v84
    s_cbranch_vccz L_GO_F
    global_load_dword v84, v85, s[48:49] offset:1024 sc1
    s_waitcnt vmcnt(15)
    v_cmp_gt_u32 vcc, s69, v84
    s_cbranch_vccz L_GO_F
    global_load_dword v84, v85, s[48:49] offset:1024 sc1
    s_waitcnt vmcnt(15)
    v_cmp_gt_u32 vcc, s69, v84
    s_cbranch_vccz L_GO_F
    global_load_dword v84, v85, s[48:49] offset:1024 sc1
    s_waitcnt vmcnt(15)
    v_cmp_gt_u32 vcc, s69, v84
    s_cbranch_vccz L_GO_F
    global_load_dword v84, v85, s[48:49] offset:1024 sc1
    s_waitcnt vmcnt(15)
    v_cmp_gt_u32 vcc, s69, v84
    s_cbranch_vccz L_GO_F
    global_load_dword v84, v85, s[48:49] offset:1024 sc1
    s_waitcnt vmcnt(15)
    v_cmp_gt_u32 vcc, s69, v84
    s_cbranch_vccz L_GO_F
    global_load_dword v84, v85, s[48:49] offset:1024 sc1
    s_waitcnt vmcnt(15)
    v_cmp_gt_u32 vcc, s69, v84
    s_cbranch_vccz L_GO_F
    global_load_dword v84, v85, s[48:49] offset:1024 sc1
    s_waitcnt vmcnt(15)
    v_cmp_gt_u32 vcc, s69, v84
    s_cbranch_vccz L_GO_F
    global_load_dword v84, v85, s[48:49] offset:1024 sc1
    s_waitcnt vmcnt(15)
    v_cmp_gt_u32 vcc, s69, v84
    s_cbranch_vccz L_GO_F
    global_load_dword v84, v85, s[48:49] offset:1024 sc1
    s_waitcnt vmcnt(15)
    v_cmp_gt_u32 vcc, s69, v84
    s_cbranch_vccz L_GO_F
    global_load_dword v84, v85, s[48:49] offset:1024 sc1
    s_waitcnt vmcnt(15)
    v_cmp_gt_u32 vcc, s69, v84
    s_cbranch_vccz L_GO_F
    global_load_dword v84, v85, s[48:49] offset:1024 sc1
    s_waitcnt vmcnt(15)
    v_cmp_gt_u32 vcc, s69, v84
    s_cbranch_vccz L_GO_F
    s_branch L_GP_F
    s_branch L_LOOP_F
L_NORS_F:
    s_waitcnt vmcnt(0)
    s_barrier
    s_xor_b32 s26, s26, 0x40000
    s_add_u32 s63, s69, 7
    v_lshrrev_b32 v18, 2, v13
    v_sub_u32 v18, s63, v18
    v_mul_u32_u24 v18, 10923, v18
    v_lshrrev_b32 v18, 16, v18
L_KVP_F:
    v_cmp_gt_u32 vcc, v18, v19
    s_nop 0
    s_and_b32 s64, vcc_lo, 0x3f
    s_cbranch_scc0 L_LOOP_F
    buffer_load_dword v19, v13, s[52:55], 0 offen sc1
    s_sub_u32 s61, s61, 1
    s_cbranch_scc1 L_END
    s_waitcnt vmcnt(0)
    s_branch L_KVP_F
L_MAX_F:
    s_nop 7
    ds_read_b128 v[128:131], v10 offset:8192
    ds_read_b128 v[132:135], v10 offset:9216
    ds_read_b128 v[104:107], v10 offset:10240
    ds_read_b128 v[112:115], v10 offset:11264
    ds_read_b128 v[116:119], v8 offset:12288
    s_waitcnt lgkmcnt(0)
    v_add_f32 v128, v128, v132
    v_add_f32 v104, v104, v112
    v_add_f32 v128, v128, v104
    v_add_f32 v129, v129, v133
    v_add_f32 v105, v105, v113
    v_add_f32 v129, v129, v105
    v_add_f32 v130, v130, v134
    v_add_f32 v106, v106, v114
    v_add_f32 v130, v130, v106
    v_add_f32 v131, v131, v135
    v_add_f32 v107, v107, v115
    v_add_f32 v131, v131, v107
    v_add_f32 v116, v116, v117
    v_add_f32 v118, v118, v119
    v_add_f32 v116, v116, v118
    v_mul_f32 v116, s81, v116
    v_max3_f32 v132, v128, v129, v130
    v_max3_f32 v132, v131, v116, v132
    s_nop 1
    v_max_f32_dpp v133, v132, v132 quad_perm:[2,3,0,1] row_mask:0xf bank_mask:0xf
    v_mov_b32 v134, v133
    s_nop 1
    v_permlane16_swap_b32 v133, v134
    v_max_f32 v132, v133, v134
    v_mov_b32 v133, v132
    s_nop 1
    v_permlane32_swap_b32 v132, v133
    v_max_f32 v132, v132, v133
    v_sub_f32 v128, v128, v132
    v_exp_f32 v128, v128
    v_sub_f32 v129, v129, v132
    v_exp_f32 v129, v129
    v_sub_f32 v130, v130, v132
    v_exp_f32 v130, v130
    v_sub_f32 v131, v131, v132
    v_exp_f32 v131, v131
    v_sub_f32 v116, v116, v132
    v_exp_f32 v116, v116
    v_cvt_pk_bf16_f32 v132, v128, v129
    v_cvt_pk_bf16_f32 v133, v130, v131
    v_mov_b32_dpp v118, v116 quad_perm:[0,1,0,1] row_mask:0xf bank_mask:0xf
    v_mov_b32_dpp v119, v116 quad_perm:[2,3,2,3] row_mask:0xf bank_mask:0xf
    v_mov_b32_dpp v104, v132 quad_perm:[0,1,0,1] row_mask:0xf bank_mask:0xf
    v_mov_b32_dpp v106, v132 quad_perm:[2,3,2,3] row_mask:0xf bank_mask:0xf
    v_mov_b32_dpp v105, v133 quad_perm:[0,1,0,1] row_mask:0xf bank_mask:0xf
    v_mov_b32_dpp v107, v133 quad_perm:[2,3,2,3] row_mask:0xf bank_mask:0xf
    v_cvt_pk_bf16_f32 v20, v118, v119
    v_cvt_pk_bf16_f32 v23, v118, v119
    v_mov_b64 v[112:113], s[82:83]
    v_mov_b64 v[114:115], s[82:83]
    s_nop 1
    v_mfma_f32_16x16x32_bf16 v[72:75], v[112:115], v[104:107], 0
    v_mfma_f32_16x16x32_bf16 v[128:131], v[136:139], v[104:107], 0
    v_mfma_f32_16x16x32_bf16 v[132:135], v[140:143], v[104:107], 0
    v_mfma_f32_16x16x16_bf16 v[72:75], v[112:113], v[20:21], v[72:75]
    v_mfma_f32_16x16x16_bf16 v[128:131], v[120:121], v[20:21], v[128:131]
    v_mfma_f32_16x16x16_bf16 v[132:135], v[120:121], v[22:23], v[132:135]
    s_nop 7
    v_rcp_f32 v74, v72
    s_mov_b64 vcc, 0
    s_branch L_MAXED2_F
L_BFAIL_F:
    v_max3_u32 v18, v72, v73, v74
    v_max3_u32 v18, v75, v76, v18
    v_max3_u32 v18, v77, v78, v18
    v_max3_u32 v18, v79, v80, v18
    v_max3_u32 v18, v81, v82, v18
    v_max3_u32 v18, v83, v84, v18
    v_max3_u32 v18, v85, v86, v18
    v_max3_u32 v18, v87, v88, v18
    v_max3_u32 v18, v89, v90, v18
    v_max3_u32 v18, v91, v92, v18
    v_max3_u32 v18, v93, v94, v18
    v_max3_u32 v18, v95, v96, v18
    v_max3_u32 v18, v97, v98, v18
    v_max3_u32 v18, v99, v100, v18
    v_max3_u32 v18, v101, v102, v18
    v_max_u32 v18, v103, v18
    v_cmp_eq_u32 vcc, -1, v18
    s_cbranch_vccz L_BOK_F
    s_waitcnt lgkmcnt(0)
    s_barrier
    v_mov_b64 v[104:105], 0
    v_mov_b64 v[106:107], 0
    v_mov_b64 v[108:109], 0
    v_mov_b64 v[110:111], 0
    v_mov_b64 v[112:113], 0
    v_mov_b64 v[114:115], 0
    v_mov_b64 v[116:117], 0
    v_mov_b64 v[118:119], 0
    v_mov_b64 v[120:121], 0
    v_mov_b64 v[122:123], 0
    v_mov_b64 v[124:125], 0
    v_mov_b64 v[126:127], 0
    ds_read_b128 v[24:27], v11 offset:0
    ds_read_b128 v[28:31], v11 offset:1024
    ds_read_b128 v[32:35], v11 offset:2048
    ds_read_b128 v[36:39], v11 offset:3072
    ds_read_b128 v[40:43], v11 offset:8192
    ds_read_b128 v[44:47], v11 offset:9216
    ds_read_b128 v[48:51], v11 offset:10240
    ds_read_b128 v[52:55], v11 offset:11264
L_BP_F:
    global_load_dwordx4 v[72:75], v1, s[8:9] sc1
    global_load_dwordx4 v[76:79], v1, s[10:11] sc1
    s_sub_u32 s61, s61, 1
    s_cbranch_scc1 L_END
    s_waitcnt vmcnt(0)
    v_max3_u32 v18, v72, v73, v74
    v_max3_u32 v18, v75, v76, v18
    v_max3_u32 v18, v77, v78, v18
    v_max_u32 v18, v18, v79
    v_cmp_eq_u32 vcc, -1, v18
    s_cbranch_vccnz L_BP_F
    ds_write_b128 v2, v[76:79] offset:1024
    s_branch L_ENT_F
L_AFAIL_F:
    s_sub_u32 s61, s61, 1
    s_cbranch_scc1 L_END
    s_and_b32 s63, s61, 15
    s_cbranch_scc0 L_ATREE_F
L_ARL_F:
    global_load_dwordx4 v[72:75], v122, s[24:25] offset:-4096 sc1
    global_load_dwordx4 v[76:79], v122, s[24:25] offset:-3968 sc1
    global_load_dwordx4 v[80:83], v122, s[24:25] offset:0 sc1
    global_load_dwordx4 v[84:87], v122, s[24:25] offset:128 sc1
    global_load_dwordx4 v[88:91], v122, s[34:35] offset:-4096 sc1
    global_load_dwordx4 v[92:95], v122, s[34:35] offset:-3968 sc1
    global_load_dwordx4 v[96:99], v122, s[34:35] offset:0 sc1
    global_load_dwordx4 v[100:103], v122, s[34:35] offset:128 sc1
    buffer_load_dword v116, v13, s[48:51], 0 offen sc1
    s_branch L_ARE_F
L_ATREE_F:
    v_max3_u32 v18, v72, v73, v74
    v_max3_u32 v18, v75, v76, v18
    v_max3_u32 v18, v77, v78, v18
    v_max3_u32 v18, v79, v80, v18
    v_max3_u32 v18, v81, v82, v18
    v_max3_u32 v18, v83, v84, v18
    v_max3_u32 v18, v85, v86, v18
    v_max3_u32 v18, v87, v88, v18
    v_max3_u32 v18, v89, v90, v18
    v_max3_u32 v18, v91, v92, v18
    v_max3_u32 v18, v93, v94, v18
    v_max3_u32 v18, v95, v96, v18
    v_max3_u32 v18, v97, v98, v18
    v_max3_u32 v18, v99, v100, v18
    v_max3_u32 v18, v101, v102, v18
    v_max_u32 v18, v103, v18
    v_min_u32 v124, -2, v124
    v_cmp_eq_u32 vcc, -1, v18
    s_cbranch_vccz L_AOK_F
    s_branch L_ARL_F
.p2align 6
L_GO_S:
    s_nop 15
    s_nop 7
L_LOOP_S:
    s_barrier
    global_load_dwordx4 v[72:75], v1, s[8:9] sc1
    s_nop 11
    global_load_lds_dwordx4 v1, s[10:11] sc1
    s_cmp_eq_u32 s69, 63
    s_cbranch_scc1 L_LAST
    s_nop 15
    s_nop 0
L_ENT0_S:
    buffer_store_dword v23, v13, s[44:47], 0 offen sc1
    global_store_dwordx4 v0, v[100:103], s[30:31] sc1
    global_load_dwordx4 v[56:59], v0, s[28:29] offset:0 sc1
L_ENT_S:
    s_waitcnt vmcnt(4) lgkmcnt(0)
    ds_write_b128 v2, v[72:75]
    v_smfmac_f32_16x16x64_bf16 v[104:107], v[72:75], a[0:7], v15
    v_smfmac_f32_16x16x64_bf16 v[112:115], v[72:75], a[8:15], v15
    v_smfmac_f32_16x16x64_bf16 v[120:123], v[72:75], v[24:31], v15
    s_waitcnt vmcnt(3) lgkmcnt(0)
    s_barrier
    ds_read_b128 v[76:79], v2 offset:1024
    ds_read_b128 v[80:83], v3 offset:0
    v_smfmac_f32_16x16x64_bf16 v[124:127], v[72:75], v[32:39], v15
    ds_read_b128 v[84:87], v3 offset:1024
    global_load_dwordx4 v[60:63], v0, s[28:29] offset:1024 sc1
    v_smfmac_f32_16x16x64_bf16 v[108:111], v[72:75], a[128:135], v15
    ds_read_b128 v[88:91], v4 offset:0
    v_smfmac_f32_16x16x64_bf16 v[116:119], v[72:75], a[136:143], v15
    ds_read_b128 v[92:95], v4 offset:1024
    buffer_load_dword v19, v13, s[52:55], 0 offen sc1
    s_waitcnt lgkmcnt(4)
    v_smfmac_f32_16x16x64_bf16 v[104:107], v[76:79], a[16:23], v15
    ds_read_b128 v[96:99], v5 offset:0
    v_smfmac_f32_16x16x64_bf16 v[112:115], v[76:79], a[24:31], v15
    ds_read_b128 v[100:103], v5 offset:1024
    global_load_dwordx4 v[64:67], v0, s[28:29] offset:2048 sc1
    s_waitcnt lgkmcnt(4)
    v_smfmac_f32_16x16x64_bf16 v[104:107], v[80:83], a[32:39], v15
    ds_read_b128 v[24:27], v11 offset:4096
    v_smfmac_f32_16x16x64_bf16 v[112:115], v[80:83], a[40:47], v15
    ds_read_b128 v[28:31], v11 offset:5120
    v_smfmac_f32_16x16x64_bf16 v[104:107], v[84:87], a[48:55], v15
    ds_read_b128 v[32:35], v11 offset:6144
    v_smfmac_f32_16x16x64_bf16 v[112:115], v[84:87], a[56:63], v15
    ds_read_b128 v[36:39], v11 offset:7168
    global_load_dwordx4 v[68:71], v0, s[28:29] offset:3072 sc1
    s_waitcnt lgkmcnt(4)
    v_smfmac_f32_16x16x64_bf16 v[104:107], v[88:91], a[64:71], v15
    v_smfmac_f32_16x16x64_bf16 v[104:107], v[92:95], a[80:87], v15
    v_smfmac_f32_16x16x64_bf16 v[104:107], v[96:99], a[96:103], v15
    v_smfmac_f32_16x16x64_bf16 v[104:107], v[100:103], a[112:119], v15
    global_store_dword v13, v9, s[26:27] offset:768 sc1
    v_smfmac_f32_16x16x64_bf16 v[112:115], v[88:91], a[72:79], v15
    global_store_dword v13, v9, s[26:27] offset:1024 sc1
    v_smfmac_f32_16x16x64_bf16 v[112:115], v[92:95], a[88:95], v15
    v_add_f32 v104, v104, v106
    v_smfmac_f32_16x16x64_bf16 v[112:115], v[96:99], a[104:111], v15
    v_add_f32 v105, v105, v107
    v_smfmac_f32_16x16x64_bf16 v[112:115], v[100:103], a[120:127], v15
    v_cmp_u_f32 vcc, v104, v105
    v_smfmac_f32_16x16x64_bf16 v[120:123], v[76:79], v[40:47], v15
    s_cbranch_vccnz L_BFAIL_S
L_BOK_S:
    v_cvt_pk_bf16_f32 v73, v104, v105
    v_smfmac_f32_16x16x64_bf16 v[124:127], v[76:79], v[48:55], v15
    ds_read_b128 v[40:43], v11 offset:12288
    v_add_f32 v112, v112, v114
    v_add_f32 v113, v113, v115
    v_cvt_pk_bf16_f32 v75, v112, v113
    v_mfma_f32_16x16x16_bf16 v[104:107], v[72:73], v[16:17], 0
    ds_read_b128 v[44:47], v11 offset:13312
    s_add_u32 s69, s69, 1
    v_mfma_f32_16x16x16_bf16 v[112:115], v[74:75], v[16:17], 0
    ds_read_b128 v[48:51], v11 offset:14336
    v_mov_b32 v18, s69
    v_smfmac_f32_16x16x64_bf16 v[108:111], v[76:79], a[144:151], v15
    ds_read_b128 v[52:55], v11 offset:15360
    v_cvt_pk_bf16_f32 v104, v104, v105
    v_cvt_pk_bf16_f32 v105, v106, v107
    v_cvt_pk_bf16_f32 v106, v112, v113
    v_cvt_pk_bf16_f32 v107, v114, v115
    v_smfmac_f32_16x16x64_bf16 v[108:111], v[80:83], a[160:167], v15
    global_store_dword v13, v9, s[26:27] offset:1280 sc1
    v_mfma_f32_16x16x32_bf16 v[112:115], v[104:107], v[128:131], 0
    global_store_dword v13, v9, s[26:27] offset:1536 sc1
    v_mfma_f32_16x16x32_bf16 v[128:131], v[104:107], v[132:135], 0
    global_store_dword v13, v9, s[26:27] offset:1792 sc1
    v_smfmac_f32_16x16x64_bf16 v[108:111], v[84:87], a[176:183], v15
    ds_write2_b32 v6, v114, v115 offset0:0 offset1:4
    v_smfmac_f32_16x16x64_bf16 v[108:111], v[88:91], a[192:199], v15
    ds_write2_b32 v14, v130, v131 offset0:0 offset1:4
    v_smfmac_f32_16x16x64_bf16 v[108:111], v[92:95], a[208:215], v15
    global_store_dword v13, v9, s[26:27] offset:0 sc1
    v_smfmac_f32_16x16x64_bf16 v[108:111], v[96:99], a[224:231], v15
    global_store_dword v13, v9, s[26:27] offset:256 sc1
    v_smfmac_f32_16x16x64_bf16 v[108:111], v[100:103], a[240:247], v15
    global_store_dword v13, v9, s[26:27] offset:512 sc1
    v_smfmac_f32_16x16x64_bf16 v[116:119], v[76:79], a[152:159], v15
    v_smfmac_f32_16x16x64_bf16 v[116:119], v[80:83], a[168:175], v15
    s_waitcnt lgkmcnt(0)
    s_barrier
    v_smfmac_f32_16x16x64_bf16 v[116:119], v[84:87], a[184:191], v15
    ds_read_b128 v[128:131], v10 offset:8192
    v_add_f32 v108, v108, v110
    v_smfmac_f32_16x16x64_bf16 v[116:119], v[88:91], a[200:207], v15
    ds_read_b128 v[132:135], v10 offset:9216
    v_add_f32 v109, v109, v111
    v_smfmac_f32_16x16x64_bf16 v[116:119], v[92:95], a[216:223], v15
    ds_read_b128 v[104:107], v10 offset:10240
    v_cvt_pk_bf16_f32 v72, v108, v109
    v_smfmac_f32_16x16x64_bf16 v[116:119], v[96:99], a[232:239], v15
    ds_read_b128 v[112:115], v10 offset:11264
    v_smfmac_f32_16x16x64_bf16 v[116:119], v[100:103], a[248:255], v15
    v_smfmac_f32_16x16x64_bf16 v[120:123], v[80:83], v[24:31], v15
    s_waitcnt lgkmcnt(2)
    v_add_f32 v128, v128, v132
    v_mfma_f32_16x16x16_bf16 v[108:111], v[72:73], v[16:17], 0
    v_add_f32 v116, v116, v118
    v_add_f32 v117, v117, v119
    v_cvt_pk_bf16_f32 v74, v116, v117
    v_add_f32 v129, v129, v133
    v_add_f32 v130, v130, v134
    v_mfma_f32_16x16x16_bf16 v[116:119], v[74:75], v[16:17], 0
    s_waitcnt lgkmcnt(0)
    v_cvt_pk_bf16_f32 v76, v108, v109
    v_cvt_pk_bf16_f32 v77, v110, v111
    v_add_f32 v131, v131, v135
    v_add_f32 v104, v104, v112
    v_smfmac_f32_16x16x64_bf16 v[124:127], v[80:83], v[32:39], v15
    ds_read_b128 v[24:27], v11 offset:16384
    v_cvt_pk_bf16_f32 v78, v116, v117
    v_cvt_pk_bf16_f32 v79, v118, v119
    v_add_f32 v105, v105, v113
    v_add_f32 v128, v128, v104
    v_mfma_f32_16x16x32_bf16 v[108:111], v[76:79], v[76:79], 0
    v_add_f32 v129, v129, v105
    v_add_f32 v106, v106, v114
    v_smfmac_f32_16x16x64_bf16 v[120:123], v[84:87], v[40:47], v15
    ds_read_b128 v[28:31], v11 offset:17408
    v_add_f32 v107, v107, v115
    v_smfmac_f32_16x16x64_bf16 v[124:127], v[84:87], v[48:55], v15
    ds_write2_b32 v7, v108, v109 offset0:0 offset1:8
    v_smfmac_f32_16x16x64_bf16 v[120:123], v[88:91], v[144:151], v15
    v_exp_f32 v128, v128
    v_add_f32 v130, v130, v106
    v_smfmac_f32_16x16x64_bf16 v[124:127], v[88:91], v[152:159], v15
    v_exp_f32 v129, v129
    v_add_f32 v131, v131, v107
    v_smfmac_f32_16x16x64_bf16 v[120:123], v[92:95], v[160:167], v15
    v_exp_f32 v130, v130
    v_smfmac_f32_16x16x64_bf16 v[124:127], v[92:95], v[168:175], v15
    s_waitcnt lgkmcnt(0)
    s_barrier
    v_smfmac_f32_16x16x64_bf16 v[120:123], v[96:99], v[176:183], v15
    ds_read_b128 v[116:119], v8 offset:12288
    v_exp_f32 v131, v131
    v_cvt_pk_bf16_f32 v132, v128, v129
    v_smfmac_f32_16x16x64_bf16 v[120:123], v[100:103], v[192:199], v15
    ds_read_b128 v[32:35], v11 offset:18432
    v_cvt_pk_bf16_f32 v133, v130, v131
    v_mov_b32_dpp v104, v132 quad_perm:[0,1,0,1] row_mask:0xf bank_mask:0xf
    v_smfmac_f32_16x16x64_bf16 v[124:127], v[96:99], v[184:191], v15
    ds_read_b128 v[36:39], v11 offset:19456
    v_mov_b32_dpp v106, v132 quad_perm:[2,3,2,3] row_mask:0xf bank_mask:0xf
    v_mov_b32_dpp v105, v133 quad_perm:[0,1,0,1] row_mask:0xf bank_mask:0xf
    v_smfmac_f32_16x16x64_bf16 v[124:127], v[100:103], v[200:207], v15
    ds_read_b128 v[40:43], v11 offset:20480
    s_waitcnt lgkmcnt(3)
    v_mov_b32_dpp v107, v133 quad_perm:[2,3,2,3] row_mask:0xf bank_mask:0xf
    v_add_f32 v116, v116, v117
    v_add_f32 v118, v118, v119
    v_mfma_f32_16x16x32_bf16 v[128:131], v[136:139], v[104:107], 0
    v_add_f32 v116, v116, v118
    v_mul_f32 v116, s81, v116
    v_mfma_f32_16x16x32_bf16 v[132:135], v[140:143], v[104:107], 0
    v_exp_f32 v116, v116
    v_mov_b64 v[112:113], s[82:83]
    v_mov_b64 v[114:115], s[82:83]
    v_mov_b32_dpp v118, v116 quad_perm:[0,1,0,1] row_mask:0xf bank_mask:0xf
    v_mov_b32_dpp v119, v116 quad_perm:[2,3,2,3] row_mask:0xf bank_mask:0xf
    v_mfma_f32_16x16x32_bf16 v[72:75], v[112:115], v[104:107], 0
    v_cvt_pk_bf16_f32 v20, v118, v119
    v_add_f32 v120, v120, v122
    v_add_f32 v121, v121, v123
    v_add_f32 v124, v124, v126
    v_add_f32 v125, v125, v127
    v_cvt_pk_bf16_f32 v120, v120, v121
    v_cvt_pk_bf16_f32 v121, v124, v125
    v_mfma_f32_16x16x16_bf16 v[72:75], v[112:113], v[20:21], v[72:75]
    ds_read_b128 v[44:47], v11 offset:21504
    v_cvt_pk_bf16_f32 v23, v118, v119
    v_mfma_f32_16x16x16_bf16 v[128:131], v[120:121], v[20:21], v[128:131]
    global_store_dword v21, v18, s[32:33] sc1
    ds_read_b128 v[48:51], v11 offset:22528
    ds_read_b128 v[52:55], v11 offset:23552
    v_mfma_f32_16x16x16_bf16 v[132:135], v[120:121], v[22:23], v[132:135]
    v_add_u32 v18, s79, v72
    v_rcp_f32 v74, v72
    v_cmp_le_u32 vcc, s80, v18
L_MAXED2_S:
    v_mul_f32 v128, v74, v128
    v_mul_f32 v129, v74, v129
    v_pk_mul_f32 v[130:131], v[130:131], v[74:75] op_sel_hi:[1,0]
    v_cvt_pk_bf16_f32 v108, v128, v129
    v_pk_mul_f32 v[132:133], v[132:133], v[74:75] op_sel_hi:[1,0]
    v_pk_mul_f32 v[134:135], v[134:135], v[74:75] op_sel_hi:[1,0]
    v_cvt_pk_bf16_f32 v109, v130, v131
    v_cvt_pk_bf16_f32 v110, v132, v133
    v_cvt_pk_bf16_f32 v111, v134, v135
    s_cbranch_vccnz L_MAX_S
    ds_write_b128 v2, v[108:111]
    v_mfma_f32_16x16x1_4b_f32 v[88:103], v21, v21, 0
    ds_read_b128 v[80:83], v11 offset:24576
    ds_read_b128 v[84:87], v11 offset:25600
    s_waitcnt lgkmcnt(3)
    v_smfmac_f32_16x16x64_bf16 v[88:91], v[108:111], v[24:31], v15
    s_waitcnt lgkmcnt(2)
    s_barrier
    ds_read_b128 v[128:131], v3
    v_smfmac_f32_16x16x64_bf16 v[92:95], v[108:111], v[32:39], v15
    ds_read_b128 v[132:135], v4
    ds_read_b128 v[112:115], v5
    v_smfmac_f32_16x16x64_bf16 v[96:99], v[108:111], v[40:47], v15
    ds_read_b128 v[136:139], v11 offset:26624
    v_smfmac_f32_16x16x64_bf16 v[100:103], v[108:111], v[48:55], v15
    ds_read_b128 v[140:143], v11 offset:27648
    s_waitcnt lgkmcnt(4)
    v_smfmac_f32_16x16x64_bf16 v[88:91], v[128:131], v[208:215], v15
    ds_read_b128 v[24:27], v11 offset:32768
    s_waitcnt lgkmcnt(4)
    v_smfmac_f32_16x16x64_bf16 v[88:91], v[132:135], v[240:247], v15
    ds_read_b128 v[28:31], v11 offset:33792
    s_waitcnt lgkmcnt(4)
    v_smfmac_f32_16x16x64_bf16 v[88:91], v[112:115], v[80:87], v15
    ds_read_b128 v[32:35], v11 offset:28672
    ds_read_b128 v[36:39], v11 offset:29696
    v_smfmac_f32_16x16x64_bf16 v[92:95], v[128:131], v[216:223], v15
    ds_read_b128 v[40:43], v11 offset:34816
    v_smfmac_f32_16x16x64_bf16 v[92:95], v[132:135], v[248:255], v15
    ds_read_b128 v[44:47], v11 offset:35840
    s_waitcnt lgkmcnt(6)
    v_cvt_pk_bf16_f32 v88, v88, v90
    v_smfmac_f32_16x16x64_bf16 v[92:95], v[112:115], v[136:143], v15
    global_store_dword v12, v88, s[16:17] offset:0 sc1
    v_cvt_pk_bf16_f32 v89, v89, v91
    v_smfmac_f32_16x16x64_bf16 v[96:99], v[128:131], v[224:231], v15
    global_store_dword v12, v89, s[16:17] offset:256 sc1
    ds_read_b128 v[48:51], v11 offset:30720
    s_waitcnt lgkmcnt(3)
    v_and_b32 v122, 0x380, v0
    v_smfmac_f32_16x16x64_bf16 v[96:99], v[132:135], v[24:31], v15
    ds_read_b128 v[52:55], v11 offset:31744
    buffer_load_dword v116, v13, s[48:51], 0 offen sc1
    v_cvt_pk_bf16_f32 v93, v93, v95
    v_smfmac_f32_16x16x64_bf16 v[96:99], v[112:115], v[32:39], v15
    global_store_dword v12, v93, s[18:19] offset:256 sc1
    v_cvt_pk_bf16_f32 v92, v92, v94
    v_smfmac_f32_16x16x64_bf16 v[100:103], v[128:131], v[232:239], v15
    global_store_dword v12, v92, s[18:19] offset:0 sc1
    s_waitcnt lgkmcnt(2)
    v_add_u32 v122, v122, v0
    v_smfmac_f32_16x16x64_bf16 v[100:103], v[132:135], v[40:47], v15
    s_cmp_lg_u32 s56, 0
    s_waitcnt lgkmcnt(0)
    v_cvt_pk_bf16_f32 v97, v97, v99
    v_smfmac_f32_16x16x64_bf16 v[100:103], v[112:115], v[48:55], v15
    global_store_dword v12, v97, s[20:21] offset:256 sc1
    v_cvt_pk_bf16_f32 v96, v96, v98
    global_store_dword v12, v96, s[20:21] offset:0 sc1
    v_mov_b64 v[112:113], v[76:77]
    v_mov_b64 v[114:115], v[78:79]
    v_mov_b32 v23, s69
    s_nop 0
    v_cvt_pk_bf16_f32 v100, v100, v102
    v_cvt_pk_bf16_f32 v101, v101, v103
    global_store_dword v12, v100, s[22:23] offset:0 sc1
    global_store_dword v12, v101, s[22:23] offset:256 sc1
    s_cbranch_scc1 L_OTH_S
    buffer_load_dword v117, v13, s[48:51], 0 offen sc1
    ds_read_b128 v[104:107], v8 offset:13312
    s_xor_b32 s16, s16, 0x40000
    s_xor_b32 s18, s18, 0x40000
    s_xor_b32 s20, s20, 0x40000
    s_xor_b32 s22, s22, 0x40000
    s_add_u32 s30, s30, 0x20000
    s_addc_u32 s31, s31, 0
    s_xor_b32 s8, s8, 0x2000
    s_xor_b32 s10, s10, 0x2000
    s_cmp_eq_u32 s69, 62
    buffer_load_dword v118, v13, s[48:51], 0 offen sc1
    s_cselect_b32 s4, 0, 524288
    s_add_u32 s28, s28, s4
    s_addc_u32 s29, s29, 0
    s_xor_b32 s26, s26, 0x40000
    ds_read_b128 v[24:27], v11 offset:0
    ds_read_b128 v[28:31], v11 offset:1024
    ds_read_b128 v[32:35], v11 offset:2048
    ds_read_b128 v[36:39], v11 offset:3072
    ds_read_b128 v[40:43], v11 offset:8192
    ds_read_b128 v[44:47], v11 offset:9216
    buffer_load_dword v119, v13, s[48:51], 0 offen sc1
    ds_read_b128 v[48:51], v11 offset:10240
    ds_read_b128 v[52:55], v11 offset:11264
    s_nop 7
    buffer_load_dword v124, v13, s[48:51], 0 offen sc1
    s_nop 7
    s_waitcnt vmcnt(10)
    v_cmp_gt_u32 vcc, s69, v116
    s_nop 0
    s_cmp_lg_u32 vcc_lo, 0
    s_cbranch_scc0 L_SOK_S
    buffer_load_dword v116, v13, s[48:51], 0 offen sc1
    s_nop 3
L_SP_S:
    s_waitcnt vmcnt(4)
    v_cmp_gt_u32 vcc, s69, v117
    s_nop 0
    s_cmp_lg_u32 vcc_lo, 0
    s_cbranch_scc0 L_SLATE_S
    buffer_load_dword v117, v13, s[48:51], 0 offen sc1
    s_nop 3
    s_waitcnt vmcnt(4)
    v_cmp_gt_u32 vcc, s69, v118
    s_nop 0
    s_cmp_lg_u32 vcc_lo, 0
    s_cbranch_scc0 L_SLATE_S
    buffer_load_dword v118, v13, s[48:51], 0 offen sc1
    s_nop 3
    s_waitcnt vmcnt(4)
    v_cmp_gt_u32 vcc, s69, v119
    s_nop 0
    s_cmp_lg_u32 vcc_lo, 0
    s_cbranch_scc0 L_SLATE_S
    buffer_load_dword v119, v13, s[48:51], 0 offen sc1
    s_nop 3
    s_waitcnt vmcnt(4)
    v_cmp_gt_u32 vcc, s69, v124
    s_nop 0
    s_cmp_lg_u32 vcc_lo, 0
    s_cbranch_scc0 L_SLATE_S
    buffer_load_dword v124, v13, s[48:51], 0 offen sc1
    s_nop 3
    s_waitcnt vmcnt(4)
    v_cmp_gt_u32 vcc, s69, v116
    s_nop 0
    s_cmp_lg_u32 vcc_lo, 0
    s_cbranch_scc0 L_SLATE_S
    buffer_load_dword v116, v13, s[48:51], 0 offen sc1
    s_sub_u32 s61, s61, 1
    s_cbranch_scc1 L_END
    s_branch L_SP_S
L_SLATE_S:
    s_nop 15
    s_nop 15
    s_nop 3
L_SOK_S:
    global_load_dwordx4 v[72:75], v122, s[24:25] offset:-4096 sc1
    global_load_dwordx4 v[76:79], v122, s[24:25] offset:-3968 sc1
    global_load_dwordx4 v[80:83], v122, s[24:25] offset:0 sc1
    global_load_dwordx4 v[84:87], v122, s[24:25] offset:128 sc1
    global_load_dwordx4 v[88:91], v122, s[34:35] offset:-4096 sc1
    global_load_dwordx4 v[92:95], v122, s[34:35] offset:-3968 sc1
    global_load_dwordx4 v[96:99], v122, s[34:35] offset:0 sc1
    global_load_dwordx4 v[100:103], v122, s[34:35] offset:128 sc1
    s_mov_b64 exec, s[84:85]
    global_store_dword v0, v23, s[32:33] offset:1024 sc1
    s_mov_b64 exec, -1
    v_mov_b64 v[128:129], v[56:57]
    v_mov_b64 v[130:131], v[58:59]
    v_mov_b64 v[132:133], v[60:61]
    v_mov_b64 v[134:135], v[62:63]
    v_mov_b64 v[136:137], v[64:65]
    v_mov_b64 v[138:139], v[66:67]
    v_mov_b64 v[140:141], v[68:69]
    v_mov_b64 v[142:143], v[70:71]
    s_barrier
    s_waitcnt lgkmcnt(8)
L_ARE_S:
    s_waitcnt vmcnt(8)
    v_mfma_f32_16x16x32_bf16 v[108:111], v[104:107], v[72:75], 0
    s_waitcnt vmcnt(7)
    v_mfma_f32_16x16x32_bf16 v[108:111], v[104:107], v[76:79], v[108:111]
    s_waitcnt vmcnt(6)
    v_mfma_f32_16x16x32_bf16 v[108:111], v[104:107], v[80:83], v[108:111]
    s_waitcnt vmcnt(5)
    v_mfma_f32_16x16x32_bf16 v[108:111], v[104:107], v[84:87], v[108:111]
    s_waitcnt vmcnt(4)
    v_mfma_f32_16x16x32_bf16 v[108:111], v[104:107], v[88:91], v[108:111]
    s_waitcnt vmcnt(3)
    v_mfma_f32_16x16x32_bf16 v[108:111], v[104:107], v[92:95], v[108:111]
    s_waitcnt vmcnt(2)
    v_mfma_f32_16x16x32_bf16 v[108:111], v[104:107], v[96:99], v[108:111]
    s_waitcnt vmcnt(1)
    v_mfma_f32_16x16x32_bf16 v[108:111], v[104:107], v[100:103], v[108:111]
    s_nop 6
    s_nop 0
    v_cmp_u_f32 vcc, v108, v108
    v_cvt_pk_bf16_f32 v124, v108, v109
    s_cbranch_vccnz L_AFAIL_S
L_AOK_S:
    global_store_dword v13, v124, s[12:13] sc1
    global_store_dword v13, v9, s[14:15] sc1
    s_xor_b32 s24, s24, 0x40000
    s_xor_b32 s34, s34, 0x40000
    s_mov_b64 vcc, s[0:1]
    v_cndmask_b32_dpp v100, v120, v112, vcc quad_perm:[0,1,0,1] row_mask:0xf bank_mask:0xf
    v_cndmask_b32_dpp v101, v121, v113, vcc quad_perm:[0,1,0,1] row_mask:0xf bank_mask:0xf
    v_cndmask_b32 v102, v120, v114, vcc
    v_cndmask_b32 v103, v121, v115, vcc
    v_mov_b64 v[104:105], 0
    v_mov_b64 v[106:107], 0
    v_mov_b64 v[108:109], 0
    v_mov_b64 v[110:111], 0
    v_mov_b64 v[112:113], 0
    v_mov_b64 v[114:115], 0
    v_mov_b64 v[116:117], 0
    v_mov_b64 v[118:119], 0
    v_mov_b64 v[120:121], 0
    v_mov_b64 v[122:123], 0
    v_mov_b64 v[124:125], 0
    v_mov_b64 v[126:127], 0
    v_mov_b64 v[80:81], -1
    v_mov_b64 v[82:83], -1
    s_xor_b32 s12, s12, 0x2000
    s_xor_b32 s14, s14, 0x2000
    s_branch L_LOOP_S
.p2align 6
L_OTH_S:
    s_mov_b64 vcc, s[0:1]
    v_cndmask_b32_dpp v100, v120, v112, vcc quad_perm:[0,1,0,1] row_mask:0xf bank_mask:0xf
    v_cndmask_b32_dpp v101, v121, v113, vcc quad_perm:[0,1,0,1] row_mask:0xf bank_mask:0xf
    v_cndmask_b32 v102, v120, v114, vcc
    v_cndmask_b32 v103, v121, v115, vcc
    v_mov_b64 v[104:105], 0
    v_mov_b64 v[106:107], 0
    v_mov_b64 v[108:109], 0
    v_mov_b64 v[110:111], 0
    v_mov_b64 v[112:113], 0
    v_mov_b64 v[114:115], 0
    v_mov_b64 v[116:117], 0
    v_mov_b64 v[118:119], 0
    v_mov_b64 v[120:121], 0
    v_mov_b64 v[122:123], 0
    v_mov_b64 v[124:125], 0
    v_mov_b64 v[126:127], 0
    s_cmp_eq_u32 s69, 62
    s_cselect_b32 s4, 0, 524288
    s_add_u32 s28, s28, s4
    s_addc_u32 s29, s29, 0
    v_mov_b32 v23, s69
    s_waitcnt vmcnt(9)
    v_mov_b64 v[128:129], v[56:57]
    v_mov_b64 v[130:131], v[58:59]
    v_mov_b64 v[132:133], v[60:61]
    v_mov_b64 v[134:135], v[62:63]
    v_mov_b64 v[136:137], v[64:65]
    v_mov_b64 v[138:139], v[66:67]
    v_mov_b64 v[140:141], v[68:69]
    v_mov_b64 v[142:143], v[70:71]
    ds_read_b128 v[24:27], v11 offset:0
    ds_read_b128 v[28:31], v11 offset:1024
    ds_read_b128 v[32:35], v11 offset:2048
    ds_read_b128 v[36:39], v11 offset:3072
    ds_read_b128 v[40:43], v11 offset:8192
    ds_read_b128 v[44:47], v11 offset:9216
    ds_read_b128 v[48:51], v11 offset:10240
    ds_read_b128 v[52:55], v11 offset:11264
    s_xor_b32 s16, s16, 0x40000
    s_xor_b32 s18, s18, 0x40000
    s_xor_b32 s20, s20, 0x40000
    s_xor_b32 s22, s22, 0x40000
    s_add_u32 s30, s30, 0x20000
    s_addc_u32 s31, s31, 0
    s_xor_b32 s8, s8, 0x2000
    s_xor_b32 s10, s10, 0x2000
    v_mov_b64 v[80:81], -1
    v_mov_b64 v[82:83], -1
    s_cmp_eq_u32 s56, 3
    s_cbranch_scc1 L_NORS_S
    s_xor_b32 s26, s26, 0x40000
    s_waitcnt vmcnt(0)
    s_barrier
    s_cmp_lg_u32 s56, 2
    s_cbranch_scc1 L_LOOP_S
    v_mov_b32 v84, 0
    v_and_b32 v85, 127, v13
    s_branch L_GP_S
.p2align 6
L_GP_S:
    s_sub_u32 s61, s61, 1
    s_cbranch_scc1 L_END
    global_load_dword v84, v85, s[48:49] offset:1024 sc1
    s_waitcnt vmcnt(15)
    v_cmp_gt_u32 vcc, s69, v84
    s_cbranch_vccz L_GO_S
    global_load_dword v84, v85, s[48:49] offset:1024 sc1
    s_waitcnt vmcnt(15)
    v_cmp_gt_u32 vcc, s69, v84
    s_cbranch_vccz L_GO_S
    global_load_dword v84, v85, s[48:49] offset:1024 sc1
    s_waitcnt vmcnt(15)
    v_cmp_gt_u32 vcc, s69, v84
    s_cbranch_vccz L_GO_S
    global_load_dword v84, v85, s[48:49] offset:1024 sc1
    s_waitcnt vmcnt(15)
    v_cmp_gt_u32 vcc, s69, v84
    s_cbranch_vccz L_GO_S
    global_load_dword v84, v85, s[48:49] offset:1024 sc1
    s_waitcnt vmcnt(15)
    v_cmp_gt_u32 vcc, s69, v84
    s_cbranch_vccz L_GO_S
    global_load_dword v84, v85, s[48:49] offset:1024 sc1
    s_waitcnt vmcnt(15)
    v_cmp_gt_u32 vcc, s69, v84
    s_cbranch_vccz L_GO_S
    global_load_dword v84, v85, s[48:49] offset:1024 sc1
    s_waitcnt vmcnt(15)
    v_cmp_gt_u32 vcc, s69, v84
    s_cbranch_vccz L_GO_S
    global_load_dword v84, v85, s[48:49] offset:1024 sc1
    s_waitcnt vmcnt(15)
    v_cmp_gt_u32 vcc, s69, v84
    s_cbranch_vccz L_GO_S
    global_load_dword v84, v85, s[48:49] offset:1024 sc1
    s_waitcnt vmcnt(15)
    v_cmp_gt_u32 vcc, s69, v84
    s_cbranch_vccz L_GO_S
    global_load_dword v84, v85, s[48:49] offset:1024 sc1
    s_waitcnt vmcnt(15)
    v_cmp_gt_u32 vcc, s69, v84
    s_cbranch_vccz L_GO_S
    global_load_dword v84, v85, s[48:49] offset:1024 sc1
    s_waitcnt vmcnt(15)
    v_cmp_gt_u32 vcc, s69, v84
    s_cbranch_vccz L_GO_S
    global_load_dword v84, v85, s[48:49] offset:1024 sc1
    s_waitcnt vmcnt(15)
    v_cmp_gt_u32 vcc, s69, v84
    s_cbranch_vccz L_GO_S
    global_load_dword v84, v85, s[48:49] offset:1024 sc1
    s_waitcnt vmcnt(15)
    v_cmp_gt_u32 vcc, s69, v84
    s_cbranch_vccz L_GO_S
    global_load_dword v84, v85, s[48:49] offset:1024 sc1
    s_waitcnt vmcnt(15)
    v_cmp_gt_u32 vcc, s69, v84
    s_cbranch_vccz L_GO_S
    global_load_dword v84, v85, s[48:49] offset:1024 sc1
    s_waitcnt vmcnt(15)
    v_cmp_gt_u32 vcc, s69, v84
    s_cbranch_vccz L_GO_S
    global_load_dword v84, v85, s[48:49] offset:1024 sc1
    s_waitcnt vmcnt(15)
    v_cmp_gt_u32 vcc, s69, v84
    s_cbranch_vccz L_GO_S
    s_branch L_GP_S
    s_branch L_LOOP_S
L_NORS_S:
    s_waitcnt vmcnt(0)
    s_barrier
    s_xor_b32 s26, s26, 0x40000
    s_add_u32 s63, s69, 7
    v_lshrrev_b32 v18, 2, v13
    v_sub_u32 v18, s63, v18
    v_mul_u32_u24 v18, 10923, v18
    v_lshrrev_b32 v18, 16, v18
L_KVP_S:
    v_cmp_gt_u32 vcc, v18, v19
    s_nop 0
    s_and_b32 s64, vcc_lo, 0x3f
    s_cbranch_scc0 L_LOOP_S
    buffer_load_dword v19, v13, s[52:55], 0 offen sc1
    s_sub_u32 s61, s61, 1
    s_cbranch_scc1 L_END
    s_waitcnt vmcnt(0)
    s_branch L_KVP_S
L_MAX_S:
    s_nop 7
    ds_read_b128 v[128:131], v10 offset:8192
    ds_read_b128 v[132:135], v10 offset:9216
    ds_read_b128 v[104:107], v10 offset:10240
    ds_read_b128 v[112:115], v10 offset:11264
    ds_read_b128 v[116:119], v8 offset:12288
    s_waitcnt lgkmcnt(0)
    v_add_f32 v128, v128, v132
    v_add_f32 v104, v104, v112
    v_add_f32 v128, v128, v104
    v_add_f32 v129, v129, v133
    v_add_f32 v105, v105, v113
    v_add_f32 v129, v129, v105
    v_add_f32 v130, v130, v134
    v_add_f32 v106, v106, v114
    v_add_f32 v130, v130, v106
    v_add_f32 v131, v131, v135
    v_add_f32 v107, v107, v115
    v_add_f32 v131, v131, v107
    v_add_f32 v116, v116, v117
    v_add_f32 v118, v118, v119
    v_add_f32 v116, v116, v118
    v_mul_f32 v116, s81, v116
    v_max3_f32 v132, v128, v129, v130
    v_max3_f32 v132, v131, v116, v132
    s_nop 1
    v_max_f32_dpp v133, v132, v132 quad_perm:[2,3,0,1] row_mask:0xf bank_mask:0xf
    v_mov_b32 v134, v133
    s_nop 1
    v_permlane16_swap_b32 v133, v134
    v_max_f32 v132, v133, v134
    v_mov_b32 v133, v132
    s_nop 1
    v_permlane32_swap_b32 v132, v133
    v_max_f32 v132, v132, v133
    v_sub_f32 v128, v128, v132
    v_exp_f32 v128, v128
    v_sub_f32 v129, v129, v132
    v_exp_f32 v129, v129
    v_sub_f32 v130, v130, v132
    v_exp_f32 v130, v130
    v_sub_f32 v131, v131, v132
    v_exp_f32 v131, v131
    v_sub_f32 v116, v116, v132
    v_exp_f32 v116, v116
    v_cvt_pk_bf16_f32 v132, v128, v129
    v_cvt_pk_bf16_f32 v133, v130, v131
    v_mov_b32_dpp v118, v116 quad_perm:[0,1,0,1] row_mask:0xf bank_mask:0xf
    v_mov_b32_dpp v119, v116 quad_perm:[2,3,2,3] row_mask:0xf bank_mask:0xf
    v_mov_b32_dpp v104, v132 quad_perm:[0,1,0,1] row_mask:0xf bank_mask:0xf
    v_mov_b32_dpp v106, v132 quad_perm:[2,3,2,3] row_mask:0xf bank_mask:0xf
    v_mov_b32_dpp v105, v133 quad_perm:[0,1,0,1] row_mask:0xf bank_mask:0xf
    v_mov_b32_dpp v107, v133 quad_perm:[2,3,2,3] row_mask:0xf bank_mask:0xf
    v_cvt_pk_bf16_f32 v20, v118, v119
    v_cvt_pk_bf16_f32 v23, v118, v119
    v_mov_b64 v[112:113], s[82:83]
    v_mov_b64 v[114:115], s[82:83]
    s_nop 1
    v_mfma_f32_16x16x32_bf16 v[72:75], v[112:115], v[104:107], 0
    v_mfma_f32_16x16x32_bf16 v[128:131], v[136:139], v[104:107], 0
    v_mfma_f32_16x16x32_bf16 v[132:135], v[140:143], v[104:107], 0
    v_mfma_f32_16x16x16_bf16 v[72:75], v[112:113], v[20:21], v[72:75]
    v_mfma_f32_16x16x16_bf16 v[128:131], v[120:121], v[20:21], v[128:131]
    v_mfma_f32_16x16x16_bf16 v[132:135], v[120:121], v[22:23], v[132:135]
    s_nop 7
    v_rcp_f32 v74, v72
    s_mov_b64 vcc, 0
    s_branch L_MAXED2_S
L_BFAIL_S:
    v_max3_u32 v18, v72, v73, v74
    v_max3_u32 v18, v75, v76, v18
    v_max3_u32 v18, v77, v78, v18
    v_max3_u32 v18, v79, v80, v18
    v_max3_u32 v18, v81, v82, v18
    v_max3_u32 v18, v83, v84, v18
    v_max3_u32 v18, v85, v86, v18
    v_max3_u32 v18, v87, v88, v18
    v_max3_u32 v18, v89, v90, v18
    v_max3_u32 v18, v91, v92, v18
    v_max3_u32 v18, v93, v94, v18
    v_max3_u32 v18, v95, v96, v18
    v_max3_u32 v18, v97, v98, v18
    v_max3_u32 v18, v99, v100, v18
    v_max3_u32 v18, v101, v102, v18
    v_max_u32 v18, v103, v18
    v_cmp_eq_u32 vcc, -1, v18
    s_cbranch_vccz L_BOK_S
    s_waitcnt lgkmcnt(0)
    s_barrier
    v_mov_b64 v[104:105], 0
    v_mov_b64 v[106:107], 0
    v_mov_b64 v[108:109], 0
    v_mov_b64 v[110:111], 0
    v_mov_b64 v[112:113], 0
    v_mov_b64 v[114:115], 0
    v_mov_b64 v[116:117], 0
    v_mov_b64 v[118:119], 0
    v_mov_b64 v[120:121], 0
    v_mov_b64 v[122:123], 0
    v_mov_b64 v[124:125], 0
    v_mov_b64 v[126:127], 0
    ds_read_b128 v[24:27], v11 offset:0
    ds_read_b128 v[28:31], v11 offset:1024
    ds_read_b128 v[32:35], v11 offset:2048
    ds_read_b128 v[36:39], v11 offset:3072
    ds_read_b128 v[40:43], v11 offset:8192
    ds_read_b128 v[44:47], v11 offset:9216
    ds_read_b128 v[48:51], v11 offset:10240
    ds_read_b128 v[52:55], v11 offset:11264
L_BP_S:
    global_load_dwordx4 v[72:75], v1, s[8:9] sc1
    global_load_dwordx4 v[76:79], v1, s[10:11] sc1
    s_sub_u32 s61, s61, 1
    s_cbranch_scc1 L_END
    s_waitcnt vmcnt(0)
    v_max3_u32 v18, v72, v73, v74
    v_max3_u32 v18, v75, v76, v18
    v_max3_u32 v18, v77, v78, v18
    v_max_u32 v18, v18, v79
    v_cmp_eq_u32 vcc, -1, v18
    s_cbranch_vccnz L_BP_S
    ds_write_b128 v2, v[76:79] offset:1024
    s_branch L_ENT_S
L_AFAIL_S:
    s_sub_u32 s61, s61, 1
    s_cbranch_scc1 L_END
    s_and_b32 s63, s61, 15
    s_cbranch_scc0 L_ATREE_S
L_ARL_S:
    global_load_dwordx4 v[72:75], v122, s[24:25] offset:-4096 sc1
    global_load_dwordx4 v[76:79], v122, s[24:25] offset:-3968 sc1
    global_load_dwordx4 v[80:83], v122, s[24:25] offset:0 sc1
    global_load_dwordx4 v[84:87], v122, s[24:25] offset:128 sc1
    global_load_dwordx4 v[88:91], v122, s[34:35] offset:-4096 sc1
    global_load_dwordx4 v[92:95], v122, s[34:35] offset:-3968 sc1
    global_load_dwordx4 v[96:99], v122, s[34:35] offset:0 sc1
    global_load_dwordx4 v[100:103], v122, s[34:35] offset:128 sc1
    buffer_load_dword v116, v13, s[48:51], 0 offen sc1
    s_branch L_ARE_S
L_ATREE_S:
    v_max3_u32 v18, v72, v73, v74
    v_max3_u32 v18, v75, v76, v18
    v_max3_u32 v18, v77, v78, v18
    v_max3_u32 v18, v79, v80, v18
    v_max3_u32 v18, v81, v82, v18
    v_max3_u32 v18, v83, v84, v18
    v_max3_u32 v18, v85, v86, v18
    v_max3_u32 v18, v87, v88, v18
    v_max3_u32 v18, v89, v90, v18
    v_max3_u32 v18, v91, v92, v18
    v_max3_u32 v18, v93, v94, v18
    v_max3_u32 v18, v95, v96, v18
    v_max3_u32 v18, v97, v98, v18
    v_max3_u32 v18, v99, v100, v18
    v_max3_u32 v18, v101, v102, v18
    v_max_u32 v18, v103, v18
    v_min_u32 v124, -2, v124
    v_cmp_eq_u32 vcc, -1, v18
    s_cbranch_vccz L_AOK_S
    s_branch L_ARL_S
L_LAST:
    global_load_dwordx4 v[76:79], v1, s[10:11] sc1
    s_nop 15
    s_nop 7
    buffer_store_dword v23, v13, s[44:47], 0 offen sc1
    global_store_dwordx4 v0, v[100:103], s[30:31] sc1
    s_add_u32 s30, s30, 0x20000
    s_addc_u32 s31, s31, 0
    s_waitcnt vmcnt(2) lgkmcnt(0)
L_LAST_CHK:
    ds_write_b128 v2, v[72:75]
    v_max3_u32 v18, v72, v73, v74
    v_max3_u32 v18, v75, v76, v18
    v_max3_u32 v18, v77, v78, v18
    v_max_u32 v18, v18, v79
    v_cmp_eq_u32 vcc, -1, v18
    ds_write_b128 v2, v[76:79] offset:1024
    s_cbranch_vccnz L_LAST_RETRY
    v_smfmac_f32_16x16x64_bf16 v[120:123], v[72:75], v[24:31], v15
    v_smfmac_f32_16x16x64_bf16 v[124:127], v[72:75], v[32:39], v15
    v_smfmac_f32_16x16x64_bf16 v[120:123], v[76:79], v[40:47], v15
    v_smfmac_f32_16x16x64_bf16 v[124:127], v[76:79], v[48:55], v15
    s_waitcnt lgkmcnt(0)
    s_barrier
    ds_read_b128 v[80:83], v3 offset:0
    ds_read_b128 v[84:87], v3 offset:1024
    v_smfmac_f32_16x16x64_bf16 v[108:111], v[72:75], a[128:135], v15
    ds_read_b128 v[88:91], v4 offset:0
    v_smfmac_f32_16x16x64_bf16 v[116:119], v[72:75], a[136:143], v15
    ds_read_b128 v[92:95], v4 offset:1024
    v_smfmac_f32_16x16x64_bf16 v[108:111], v[76:79], a[144:151], v15
    ds_read_b128 v[96:99], v5 offset:0
    v_smfmac_f32_16x16x64_bf16 v[116:119], v[76:79], a[152:159], v15
    ds_read_b128 v[100:103], v5 offset:1024
    s_waitcnt lgkmcnt(4)
    v_smfmac_f32_16x16x64_bf16 v[108:111], v[80:83], a[160:167], v15
    ds_read_b128 v[24:27], v11 offset:4096
    v_smfmac_f32_16x16x64_bf16 v[116:119], v[80:83], a[168:175], v15
    ds_read_b128 v[28:31], v11 offset:5120
    v_smfmac_f32_16x16x64_bf16 v[108:111], v[84:87], a[176:183], v15
    ds_read_b128 v[32:35], v11 offset:6144
    v_smfmac_f32_16x16x64_bf16 v[116:119], v[84:87], a[184:191], v15
    ds_read_b128 v[36:39], v11 offset:7168
    s_waitcnt lgkmcnt(4)
    v_smfmac_f32_16x16x64_bf16 v[108:111], v[88:91], a[192:199], v15
    ds_read_b128 v[40:43], v11 offset:12288
    v_smfmac_f32_16x16x64_bf16 v[116:119], v[88:91], a[200:207], v15
    ds_read_b128 v[44:47], v11 offset:13312
    v_smfmac_f32_16x16x64_bf16 v[108:111], v[92:95], a[208:215], v15
    ds_read_b128 v[48:51], v11 offset:14336
    v_smfmac_f32_16x16x64_bf16 v[116:119], v[92:95], a[216:223], v15
    ds_read_b128 v[52:55], v11 offset:15360
    v_smfmac_f32_16x16x64_bf16 v[108:111], v[96:99], a[224:231], v15
    v_smfmac_f32_16x16x64_bf16 v[116:119], v[96:99], a[232:239], v15
    v_smfmac_f32_16x16x64_bf16 v[108:111], v[100:103], a[240:247], v15
    v_smfmac_f32_16x16x64_bf16 v[116:119], v[100:103], a[248:255], v15
    v_smfmac_f32_16x16x64_bf16 v[120:123], v[88:91], v[144:151], v15
    v_smfmac_f32_16x16x64_bf16 v[124:127], v[88:91], v[152:159], v15
    v_add_f32 v108, v108, v110
    v_smfmac_f32_16x16x64_bf16 v[120:123], v[92:95], v[160:167], v15
    v_add_f32 v109, v109, v111
    v_smfmac_f32_16x16x64_bf16 v[124:127], v[92:95], v[168:175], v15
    v_cvt_pk_bf16_f32 v72, v108, v109
    v_smfmac_f32_16x16x64_bf16 v[120:123], v[96:99], v[176:183], v15
    v_add_f32 v116, v116, v118
    v_smfmac_f32_16x16x64_bf16 v[124:127], v[96:99], v[184:191], v15
    v_add_f32 v117, v117, v119
    v_smfmac_f32_16x16x64_bf16 v[120:123], v[100:103], v[192:199], v15
    v_cvt_pk_bf16_f32 v74, v116, v117
    v_smfmac_f32_16x16x64_bf16 v[124:127], v[100:103], v[200:207], v15
    v_mfma_f32_16x16x16_bf16 v[108:111], v[72:73], v[16:17], 0
    s_waitcnt lgkmcnt(0)
    v_mfma_f32_16x16x16_bf16 v[116:119], v[74:75], v[16:17], 0
    v_smfmac_f32_16x16x64_bf16 v[120:123], v[80:83], v[24:31], v15
    v_cvt_pk_bf16_f32 v76, v108, v109
    v_smfmac_f32_16x16x64_bf16 v[124:127], v[80:83], v[32:39], v15
    v_cvt_pk_bf16_f32 v77, v110, v111
    v_smfmac_f32_16x16x64_bf16 v[120:123], v[84:87], v[40:47], v15
    v_cvt_pk_bf16_f32 v78, v116, v117
    v_smfmac_f32_16x16x64_bf16 v[124:127], v[84:87], v[48:55], v15
    v_cvt_pk_bf16_f32 v79, v118, v119
    s_nop 0
    v_add_f32 v120, v120, v122
    v_add_f32 v121, v121, v123
    v_cvt_pk_bf16_f32 v120, v120, v121
    s_nop 0
    v_add_f32 v124, v124, v126
    v_add_f32 v125, v125, v127
    v_cvt_pk_bf16_f32 v121, v124, v125
    s_mov_b64 vcc, s[0:1]
    v_cndmask_b32_dpp v104, v120, v76, vcc quad_perm:[0,1,0,1] row_mask:0xf bank_mask:0xf
    v_cndmask_b32_dpp v105, v121, v77, vcc quad_perm:[0,1,0,1] row_mask:0xf bank_mask:0xf
    v_cndmask_b32 v106, v120, v78, vcc
    v_cndmask_b32 v107, v121, v79, vcc
    global_store_dwordx4 v0, v[104:107], s[30:31] sc1
    s_endpgm
L_LAST_RETRY:
    s_waitcnt lgkmcnt(0)
    global_load_dwordx4 v[72:75], v1, s[8:9] sc1
    global_load_dwordx4 v[76:79], v1, s[10:11] sc1
    s_sub_u32 s61, s61, 1
    s_cbranch_scc1 L_END
    s_waitcnt vmcnt(0)
    s_branch L_LAST_CHK
L_WORKER:
    s_cmp_eq_u32 s63, 7
    s_cbranch_scc1 L_HELPER
    s_sub_u32 s63, s63, 1
    s_lshr_b32 s64, s62, 3
    s_lshl_b32 s65, s63, 5
    s_add_u32 s65, s65, s64
    s_mul_i32 s57, s65, 10923
    s_lshr_b32 s57, s57, 16
    s_mul_i32 s58, s57, 6
    s_sub_u32 s58, s65, s58
    s_and_b32 s59, s57, 14
    s_cmp_eq_u32 s59, 4
    s_cselect_b32 s59, 1, 0
    s_xor_b32 s57, s57, s59
    s_lshr_b32 s59, s65, 4
    s_and_b32 s60, s65, 15
    s_cmp_lt_u32 s58, 4
    s_cselect_b32 s70, 11, 10
    v_lshlrev_b32 v1, 4, v0
    v_lshrrev_b32 v2, 4, v0
    v_and_b32 v3, 15, v0
    v_and_b32 v7, 3, v0
    v_mov_b32 v30, 0
    s_lshl_b32 s63, s56, 2
    v_add_u32 v40, s63, v2
    v_mul_u32_u24 v40, 6, v40
    v_add_u32 v40, s58, v40
    v_lshlrev_b32 v40, 13, v40
    v_lshl_add_u32 v40, v3, 4, v40
    s_lshl_b32 s63, s57, 8
    v_add_u32 v40, s63, v40
    v_add_u32 v41, 786432, v40
    v_add_u32 v42, 1572864, v40
    v_add_u32 v43, 2359296, v40
    v_add_u32 v44, 3145728, v40
    v_add_u32 v45, 3932160, v40
    s_mov_b32 s80, s22
    s_and_b32 s81, s23, 0xffff
    s_mov_b32 s82, 4194304
    s_mov_b32 s83, 0x20000
    buffer_load_dwordx4 v[60:63], v40, s[80:83], 0 offen
    s_waitcnt vmcnt(2)
    buffer_load_dwordx4 v[60:63], v41, s[80:83], 0 offen
    s_waitcnt vmcnt(2)
    buffer_load_dwordx4 v[60:63], v42, s[80:83], 0 offen
    s_waitcnt vmcnt(2)
    buffer_load_dwordx4 v[60:63], v43, s[80:83], 0 offen
    s_waitcnt vmcnt(2)
    buffer_load_dwordx4 v[60:63], v44, s[80:83], 0 offen
    s_waitcnt vmcnt(2)
    buffer_load_dwordx4 v[60:63], v45, s[80:83], 0 offen
    s_waitcnt vmcnt(2)
    s_mov_b32 s80, s24
    s_and_b32 s81, s25, 0xffff
    s_mov_b32 s82, 4194304
    s_mov_b32 s83, 0x20000
    buffer_load_dwordx4 v[60:63], v40, s[80:83], 0 offen
    s_waitcnt vmcnt(2)
    buffer_load_dwordx4 v[60:63], v41, s[80:83], 0 offen
    s_waitcnt vmcnt(2)
    buffer_load_dwordx4 v[60:63], v42, s[80:83], 0 offen
    s_waitcnt vmcnt(2)
    buffer_load_dwordx4 v[60:63], v43, s[80:83], 0 offen
    s_waitcnt vmcnt(2)
    buffer_load_dwordx4 v[60:63], v44, s[80:83], 0 offen
    s_waitcnt vmcnt(2)
    buffer_load_dwordx4 v[60:63], v45, s[80:83], 0 offen
    s_waitcnt vmcnt(2)
    s_lshl_b32 s63, s57, 7
    s_lshl_b32 s64, s58, 2
    s_add_u32 s63, s63, s64
    s_add_u32 s63, s63, 64028672
    buffer_store_dword v30, off, s[36:39], s63 sc1
    s_lshl_b32 s63, s58, 12
    s_lshl_b32 s64, s57, 7
    s_add_u32 s63, s63, s64
    s_add_u32 s63, s63, 62914560
    buffer_store_dword v30, off, s[36:39], s63 sc1
    s_lshl_b32 s63, s57, 7
    s_lshl_b32 s64, s58, 2
    s_add_u32 s63, s63, s64
    s_add_u32 s63, s63, 64040960
    buffer_store_dword v30, off, s[36:39], s63 sc1
    s_lshl_b32 s63, s58, 12
    s_lshl_b32 s64, s57, 7
    s_add_u32 s63, s63, s64
    s_add_u32 s63, s63, 62947328
    buffer_store_dword v30, off, s[36:39], s63 sc1
    s_add_u32 s63, s58, 60
    s_and_b32 s64, s58, 6
    s_cmp_lg_u32 s64, 2
    s_cbranch_scc1 L_NOCLR2
    s_lshl_b32 s63, s63, 17
    s_lshl_b32 s64, s57, 12
    s_add_u32 s63, s63, s64
    s_lshl_b32 s64, s56, 10
    s_add_u32 s63, s63, s64
    s_add_u32 s63, s63, 33685504
    v_mov_b64 v[36:37], -1
    v_mov_b64 v[38:39], -1
    buffer_store_dwordx4 v[36:39], v1, s[36:39], s63 offen sc1
L_NOCLR2:
    v_xor_b32 v12, 0, v0
    v_lshlrev_b32 v12, 4, v12
    v_xor_b32 v13, 1, v0
    v_lshlrev_b32 v13, 4, v13
    v_xor_b32 v14, 2, v0
    v_lshlrev_b32 v14, 4, v14
    v_xor_b32 v15, 3, v0
    v_lshlrev_b32 v15, 4, v15
    v_xor_b32 v16, 4, v0
    v_lshlrev_b32 v16, 4, v16
    v_xor_b32 v17, 5, v0
    v_lshlrev_b32 v17, 4, v17
    v_xor_b32 v18, 6, v0
    v_lshlrev_b32 v18, 4, v18
    v_xor_b32 v19, 7, v0
    v_lshlrev_b32 v19, 4, v19
    v_xor_b32 v20, 8, v0
    v_lshlrev_b32 v20, 4, v20
    v_xor_b32 v21, 9, v0
    v_lshlrev_b32 v21, 4, v21
    v_xor_b32 v22, 10, v0
    v_lshlrev_b32 v22, 4, v22
    v_xor_b32 v23, 11, v0
    v_lshlrev_b32 v23, 4, v23
    v_xor_b32 v24, 12, v0
    v_lshlrev_b32 v24, 4, v24
    v_xor_b32 v25, 13, v0
    v_lshlrev_b32 v25, 4, v25
    v_xor_b32 v26, 14, v0
    v_lshlrev_b32 v26, 4, v26
    v_xor_b32 v27, 15, v0
    v_lshlrev_b32 v27, 4, v27
    s_mov_b32 s52, s16
    s_and_b32 s53, s17, 0xffff
    s_mov_b32 s54, 2097152
    s_mov_b32 s55, 0x20000
    s_mov_b32 s71, 0
    s_mov_b32 s69, s58
    s_lshl_b32 s64, s69, 15
    s_lshl_b32 s65, s56, 13
    s_add_u32 s64, s64, s65
    s_add_u32 s65, s65, s71
    s_bitcmp1_b32 s56, 0
    s_cbranch_scc1 L_xo_8
    s_add_u32 m0, s65, 0
    s_add_u32 s63, s64, 0
    buffer_load_dwordx4 v12, s[52:55], s63 offen offset:0 lds
    buffer_load_dwordx4 v13, s[52:55], s63 offen offset:1024 lds
    buffer_load_dwordx4 v14, s[52:55], s63 offen offset:2048 lds
    buffer_load_dwordx4 v15, s[52:55], s63 offen offset:3072 lds
    s_add_u32 m0, s65, 4096
    s_add_u32 s63, s64, 4096
    buffer_load_dwordx4 v16, s[52:55], s63 offen offset:0 lds
    buffer_load_dwordx4 v17, s[52:55], s63 offen offset:1024 lds
    buffer_load_dwordx4 v18, s[52:55], s63 offen offset:2048 lds
    buffer_load_dwordx4 v19, s[52:55], s63 offen offset:3072 lds
    s_branch L_xd_9
L_xo_8:
    s_add_u32 m0, s65, 0
    s_add_u32 s63, s64, 0
    buffer_load_dwordx4 v20, s[52:55], s63 offen offset:0 lds
    buffer_load_dwordx4 v21, s[52:55], s63 offen offset:1024 lds
    buffer_load_dwordx4 v22, s[52:55], s63 offen offset:2048 lds
    buffer_load_dwordx4 v23, s[52:55], s63 offen offset:3072 lds
    s_add_u32 m0, s65, 4096
    s_add_u32 s63, s64, 4096
    buffer_load_dwordx4 v24, s[52:55], s63 offen offset:0 lds
    buffer_load_dwordx4 v25, s[52:55], s63 offen offset:1024 lds
    buffer_load_dwordx4 v26, s[52:55], s63 offen offset:2048 lds
    buffer_load_dwordx4 v27, s[52:55], s63 offen offset:3072 lds
L_xd_9:
    s_mul_i32 s67, s56, 20480
    s_add_u32 s67, s67, 65536
    v_bfe_u32 v30, v0, 2, 2
    v_lshl_add_u32 v30, v2, 3, v30
    v_lshlrev_b32 v4, 13, v30
    v_lshl_add_u32 v4, v7, 4, v4
    v_lshrrev_b32 v30, 2, v0
    v_lshlrev_b32 v30, 6, v30
    v_lshl_add_u32 v5, v7, 3, v30
    v_lshl_add_u32 v6, v7, 4, v30
    v_add_u32 v5, s67, v5
    s_lshl_b32 s63, s57, 8
    s_lshl_b32 s64, s56, 6
    s_add_u32 s72, s63, s64
    s_mov_b32 s44, s22
    s_and_b32 s45, s23, 0xffff
    s_mov_b32 s46, 4194304
    s_mov_b32 s47, 0x20000
    s_mov_b32 s48, s24
    s_and_b32 s49, s25, 0xffff
    s_mov_b32 s50, 4194304
    s_mov_b32 s51, 0x20000
    s_add_u32 m0, s67, 0
    s_add_u32 s63, s72, 0
    buffer_load_dwordx4 v4, s[44:47], s63 offen  lds
    s_add_u32 m0, s67, 1024
    s_add_u32 s63, s72, 32768
    buffer_load_dwordx4 v4, s[44:47], s63 offen  lds
    s_add_u32 m0, s67, 2048
    s_add_u32 s63, s72, 262144
    buffer_load_dwordx4 v4, s[44:47], s63 offen  lds
    s_add_u32 m0, s67, 3072
    s_add_u32 s63, s72, 294912
    buffer_load_dwordx4 v4, s[44:47], s63 offen  lds
    s_add_u32 m0, s67, 4096
    s_add_u32 s63, s72, 524288
    buffer_load_dwordx4 v4, s[44:47], s63 offen  lds
    s_add_u32 m0, s67, 5120
    s_add_u32 s63, s72, 557056
    buffer_load_dwordx4 v4, s[44:47], s63 offen  lds
    s_add_u32 m0, s67, 6144
    s_add_u32 s63, s72, 786432
    buffer_load_dwordx4 v4, s[44:47], s63 offen  lds
    s_add_u32 m0, s67, 7168
    s_add_u32 s63, s72, 819200
    buffer_load_dwordx4 v4, s[44:47], s63 offen  lds
    s_add_u32 m0, s67, 8192
    s_add_u32 s63, s72, 1048576
    buffer_load_dwordx4 v4, s[44:47], s63 offen  lds
    s_add_u32 m0, s67, 9216
    s_add_u32 s63, s72, 1081344
    buffer_load_dwordx4 v4, s[44:47], s63 offen  lds
    s_add_u32 m0, s67, 10240
    s_add_u32 s63, s72, 1310720
    buffer_load_dwordx4 v4, s[44:47], s63 offen  lds
    s_add_u32 m0, s67, 11264
    s_add_u32 s63, s72, 1343488
    buffer_load_dwordx4 v4, s[44:47], s63 offen  lds
    s_add_u32 m0, s67, 12288
    s_add_u32 s63, s72, 1572864
    buffer_load_dwordx4 v4, s[44:47], s63 offen  lds
    s_add_u32 m0, s67, 13312
    s_add_u32 s63, s72, 1605632
    buffer_load_dwordx4 v4, s[44:47], s63 offen  lds
    s_add_u32 m0, s67, 14336
    s_add_u32 s63, s72, 1835008
    buffer_load_dwordx4 v4, s[44:47], s63 offen  lds
    s_add_u32 m0, s67, 15360
    s_add_u32 s63, s72, 1867776
    buffer_load_dwordx4 v4, s[44:47], s63 offen  lds
    s_waitcnt vmcnt(12)
    ds_read_b64_tr_b16 a[128:129], v5 offset:0
    ds_read_b64_tr_b16 a[130:131], v5 offset:1024
    ds_read_b64_tr_b16 a[132:133], v5 offset:2048
    ds_read_b64_tr_b16 a[134:135], v5 offset:3072
    ds_read_b64_tr_b16 a[136:137], v5 offset:32
    ds_read_b64_tr_b16 a[138:139], v5 offset:1056
    ds_read_b64_tr_b16 a[140:141], v5 offset:2080
    ds_read_b64_tr_b16 a[142:143], v5 offset:3104
    s_barrier
    s_cmp_lg_u32 s56, 0
    s_cbranch_scc1 L_na_10
    s_lshr_b32 s64, s62, 3
    s_lshl_b32 s64, 1, s64
    s_and_b32 s65, s62, 7
    s_lshl_b32 s65, s65, 5
    s_cmp_eq_u32 s96, 0
    s_cselect_b32 s64, s64, 0
    s_cselect_b32 s65, s65, 136
    v_mov_b32 v32, s64
    v_mov_b32 v33, 256
    v_lshlrev_b32 v34, 20, v0
    buffer_atomic_add_x2 v[32:33], v34, s[40:43], s65 offen sc1
L_na_10:
    s_waitcnt lgkmcnt(8)
    s_add_u32 m0, s67, 16384
    s_add_u32 s63, s72, 2097152
    buffer_load_dwordx4 v4, s[44:47], s63 offen  lds
    s_add_u32 m0, s67, 17408
    s_add_u32 s63, s72, 2129920
    buffer_load_dwordx4 v4, s[44:47], s63 offen  lds
    s_add_u32 m0, s67, 18432
    s_add_u32 s63, s72, 2359296
    buffer_load_dwordx4 v4, s[44:47], s63 offen  lds
    s_add_u32 m0, s67, 19456
    s_add_u32 s63, s72, 2392064
    buffer_load_dwordx4 v4, s[44:47], s63 offen  lds
    s_waitcnt vmcnt(12)
    ds_read_b64_tr_b16 a[144:145], v5 offset:4096
    ds_read_b64_tr_b16 a[146:147], v5 offset:5120
    ds_read_b64_tr_b16 a[148:149], v5 offset:6144
    ds_read_b64_tr_b16 a[150:151], v5 offset:7168
    ds_read_b64_tr_b16 a[152:153], v5 offset:4128
    ds_read_b64_tr_b16 a[154:155], v5 offset:5152
    ds_read_b64_tr_b16 a[156:157], v5 offset:6176
    ds_read_b64_tr_b16 a[158:159], v5 offset:7200
    v_add_u32 v30, 0, v2
    v_xor_b32 v30, v30, v3
    v_lshlrev_b32 v30, 4, v30
    v_lshl_add_u32 v8, v3, 10, v30
    v_add_u32 v8, 0, v8
    v_add_u32 v30, 4, v2
    v_xor_b32 v30, v30, v3
    v_lshlrev_b32 v30, 4, v30
    v_lshl_add_u32 v9, v3, 10, v30
    v_add_u32 v9, 0, v9
    v_add_u32 v30, 8, v2
    v_xor_b32 v30, v30, v3
    v_lshlrev_b32 v30, 4, v30
    v_lshl_add_u32 v10, v3, 10, v30
    v_add_u32 v10, 0, v10
    v_add_u32 v30, 12, v2
    v_xor_b32 v30, v30, v3
    v_lshlrev_b32 v30, 4, v30
    v_lshl_add_u32 v11, v3, 10, v30
    v_add_u32 v11, 0, v11
    v_lshlrev_b32 v32, 2, v2
    v_sub_u32 v32, v3, v32
    v_mov_b32 v33, 0x3f80
    v_mov_b32 v34, 0x3f800000
    v_mov_b32 v28, 0
    v_mov_b32 v29, 0
    v_cmp_eq_u32 vcc, 0, v32
    s_nop 1
    v_cndmask_b32 v28, v28, v33, vcc
    v_cmp_eq_u32 vcc, 1, v32
    s_nop 1
    v_cndmask_b32 v28, v28, v34, vcc
    v_cmp_eq_u32 vcc, 2, v32
    s_nop 1
    v_cndmask_b32 v29, v29, v33, vcc
    v_cmp_eq_u32 vcc, 3, v32
    s_nop 1
    v_cndmask_b32 v29, v29, v34, vcc
    s_waitcnt lgkmcnt(8)
    s_add_u32 m0, s67, 0
    s_add_u32 s63, s72, 2621440
    buffer_load_dwordx4 v4, s[44:47], s63 offen  lds
    s_add_u32 m0, s67, 1024
    s_add_u32 s63, s72, 2654208
    buffer_load_dwordx4 v4, s[44:47], s63 offen  lds
    s_add_u32 m0, s67, 2048
    s_add_u32 s63, s72, 2883584
    buffer_load_dwordx4 v4, s[44:47], s63 offen  lds
    s_add_u32 m0, s67, 3072
    s_add_u32 s63, s72, 2916352
    buffer_load_dwordx4 v4, s[44:47], s63 offen  lds
    s_waitcnt vmcnt(12)
    ds_read_b64_tr_b16 a[160:161], v5 offset:8192
    ds_read_b64_tr_b16 a[162:163], v5 offset:9216
    ds_read_b64_tr_b16 a[164:165], v5 offset:10240
    ds_read_b64_tr_b16 a[166:167], v5 offset:11264
    ds_read_b64_tr_b16 a[168:169], v5 offset:8224
    ds_read_b64_tr_b16 a[170:171], v5 offset:9248
    ds_read_b64_tr_b16 a[172:173], v5 offset:10272
    ds_read_b64_tr_b16 a[174:175], v5 offset:11296
    s_mov_b32 s80, s20
    s_and_b32 s81, s21, 0xffff
    s_mov_b32 s82, 4194304
    s_mov_b32 s83, 0x20000
    buffer_load_dwordx4 v[60:63], v40, s[80:83], 0 offen
    buffer_load_dwordx4 v[60:63], v41, s[80:83], 0 offen
    buffer_load_dwordx4 v[60:63], v42, s[80:83], 0 offen
    buffer_load_dwordx4 v[60:63], v43, s[80:83], 0 offen
    buffer_load_dwordx4 v[60:63], v44, s[80:83], 0 offen
    buffer_load_dwordx4 v[60:63], v45, s[80:83], 0 offen
    s_waitcnt lgkmcnt(8)
    s_add_u32 m0, s67, 4096
    s_add_u32 s63, s72, 3145728
    buffer_load_dwordx4 v4, s[44:47], s63 offen  lds
    s_add_u32 m0, s67, 5120
    s_add_u32 s63, s72, 3178496
    buffer_load_dwordx4 v4, s[44:47], s63 offen  lds
    s_add_u32 m0, s67, 6144
    s_add_u32 s63, s72, 3407872
    buffer_load_dwordx4 v4, s[44:47], s63 offen  lds
    s_add_u32 m0, s67, 7168
    s_add_u32 s63, s72, 3440640
    buffer_load_dwordx4 v4, s[44:47], s63 offen  lds
    s_waitcnt vmcnt(12)
    ds_read_b64_tr_b16 a[176:177], v5 offset:12288
    ds_read_b64_tr_b16 a[178:179], v5 offset:13312
    ds_read_b64_tr_b16 a[180:181], v5 offset:14336
    ds_read_b64_tr_b16 a[182:183], v5 offset:15360
    ds_read_b64_tr_b16 a[184:185], v5 offset:12320
    ds_read_b64_tr_b16 a[186:187], v5 offset:13344
    ds_read_b64_tr_b16 a[188:189], v5 offset:14368
    ds_read_b64_tr_b16 a[190:191], v5 offset:15392
    s_waitcnt lgkmcnt(8)
    s_add_u32 m0, s67, 8192
    s_add_u32 s63, s72, 3670016
    buffer_load_dwordx4 v4, s[44:47], s63 offen  lds
    s_add_u32 m0, s67, 9216
    s_add_u32 s63, s72, 3702784
    buffer_load_dwordx4 v4, s[44:47], s63 offen  lds
    s_add_u32 m0, s67, 10240
    s_add_u32 s63, s72, 3932160
    buffer_load_dwordx4 v4, s[44:47], s63 offen  lds
    s_add_u32 m0, s67, 11264
    s_add_u32 s63, s72, 3964928
    buffer_load_dwordx4 v4, s[44:47], s63 offen  lds
    s_waitcnt vmcnt(12)
    ds_read_b64_tr_b16 a[192:193], v5 offset:16384
    ds_read_b64_tr_b16 a[194:195], v5 offset:17408
    ds_read_b64_tr_b16 a[196:197], v5 offset:18432
    ds_read_b64_tr_b16 a[198:199], v5 offset:19456
    ds_read_b64_tr_b16 a[200:201], v5 offset:16416
    ds_read_b64_tr_b16 a[202:203], v5 offset:17440
    ds_read_b64_tr_b16 a[204:205], v5 offset:18464
    ds_read_b64_tr_b16 a[206:207], v5 offset:19488
    s_waitcnt lgkmcnt(8)
    s_add_u32 m0, s67, 12288
    s_add_u32 s63, s72, 0
    buffer_load_dwordx4 v4, s[48:51], s63 offen  lds
    s_add_u32 m0, s67, 13312
    s_add_u32 s63, s72, 32768
    buffer_load_dwordx4 v4, s[48:51], s63 offen  lds
    s_add_u32 m0, s67, 14336
    s_add_u32 s63, s72, 262144
    buffer_load_dwordx4 v4, s[48:51], s63 offen  lds
    s_add_u32 m0, s67, 15360
    s_add_u32 s63, s72, 294912
    buffer_load_dwordx4 v4, s[48:51], s63 offen  lds
    s_waitcnt vmcnt(12)
    ds_read_b64_tr_b16 a[208:209], v5 offset:0
    ds_read_b64_tr_b16 a[210:211], v5 offset:1024
    ds_read_b64_tr_b16 a[212:213], v5 offset:2048
    ds_read_b64_tr_b16 a[214:215], v5 offset:3072
    ds_read_b64_tr_b16 a[216:217], v5 offset:32
    ds_read_b64_tr_b16 a[218:219], v5 offset:1056
    ds_read_b64_tr_b16 a[220:221], v5 offset:2080
    ds_read_b64_tr_b16 a[222:223], v5 offset:3104
    s_waitcnt lgkmcnt(8)
    s_add_u32 m0, s67, 16384
    s_add_u32 s63, s72, 524288
    buffer_load_dwordx4 v4, s[48:51], s63 offen  lds
    s_add_u32 m0, s67, 17408
    s_add_u32 s63, s72, 557056
    buffer_load_dwordx4 v4, s[48:51], s63 offen  lds
    s_add_u32 m0, s67, 18432
    s_add_u32 s63, s72, 786432
    buffer_load_dwordx4 v4, s[48:51], s63 offen  lds
    s_add_u32 m0, s67, 19456
    s_add_u32 s63, s72, 819200
    buffer_load_dwordx4 v4, s[48:51], s63 offen  lds
    s_waitcnt vmcnt(12)
    ds_read_b64_tr_b16 a[224:225], v5 offset:4096
    ds_read_b64_tr_b16 a[226:227], v5 offset:5120
    ds_read_b64_tr_b16 a[228:229], v5 offset:6144
    ds_read_b64_tr_b16 a[230:231], v5 offset:7168
    ds_read_b64_tr_b16 a[232:233], v5 offset:4128
    ds_read_b64_tr_b16 a[234:235], v5 offset:5152
    ds_read_b64_tr_b16 a[236:237], v5 offset:6176
    ds_read_b64_tr_b16 a[238:239], v5 offset:7200
    s_waitcnt lgkmcnt(8)
    s_add_u32 m0, s67, 0
    s_add_u32 s63, s72, 1048576
    buffer_load_dwordx4 v4, s[48:51], s63 offen  lds
    s_add_u32 m0, s67, 1024
    s_add_u32 s63, s72, 1081344
    buffer_load_dwordx4 v4, s[48:51], s63 offen  lds
    s_add_u32 m0, s67, 2048
    s_add_u32 s63, s72, 1310720
    buffer_load_dwordx4 v4, s[48:51], s63 offen  lds
    s_add_u32 m0, s67, 3072
    s_add_u32 s63, s72, 1343488
    buffer_load_dwordx4 v4, s[48:51], s63 offen  lds
    s_waitcnt vmcnt(12)
    ds_read_b64_tr_b16 a[240:241], v5 offset:8192
    ds_read_b64_tr_b16 a[242:243], v5 offset:9216
    ds_read_b64_tr_b16 a[244:245], v5 offset:10240
    ds_read_b64_tr_b16 a[246:247], v5 offset:11264
    ds_read_b64_tr_b16 a[248:249], v5 offset:8224
    ds_read_b64_tr_b16 a[250:251], v5 offset:9248
    ds_read_b64_tr_b16 a[252:253], v5 offset:10272
    ds_read_b64_tr_b16 a[254:255], v5 offset:11296
    s_waitcnt lgkmcnt(8)
    s_add_u32 m0, s67, 4096
    s_add_u32 s63, s72, 1572864
    buffer_load_dwordx4 v4, s[48:51], s63 offen  lds
    s_add_u32 m0, s67, 5120
    s_add_u32 s63, s72, 1605632
    buffer_load_dwordx4 v4, s[48:51], s63 offen  lds
    s_add_u32 m0, s67, 6144
    s_add_u32 s63, s72, 1835008
    buffer_load_dwordx4 v4, s[48:51], s63 offen  lds
    s_add_u32 m0, s67, 7168
    s_add_u32 s63, s72, 1867776
    buffer_load_dwordx4 v4, s[48:51], s63 offen  lds
    s_waitcnt vmcnt(12)
    ds_read_b64_tr_b16 v[128:129], v5 offset:12288
    ds_read_b64_tr_b16 v[130:131], v5 offset:13312
    ds_read_b64_tr_b16 v[132:133], v5 offset:14336
    ds_read_b64_tr_b16 v[134:135], v5 offset:15360
    ds_read_b64_tr_b16 v[136:137], v5 offset:12320
    ds_read_b64_tr_b16 v[138:139], v5 offset:13344
    ds_read_b64_tr_b16 v[140:141], v5 offset:14368
    ds_read_b64_tr_b16 v[142:143], v5 offset:15392
    s_waitcnt lgkmcnt(8)
    s_add_u32 m0, s67, 8192
    s_add_u32 s63, s72, 2097152
    buffer_load_dwordx4 v4, s[48:51], s63 offen  lds
    s_add_u32 m0, s67, 9216
    s_add_u32 s63, s72, 2129920
    buffer_load_dwordx4 v4, s[48:51], s63 offen  lds
    s_add_u32 m0, s67, 10240
    s_add_u32 s63, s72, 2359296
    buffer_load_dwordx4 v4, s[48:51], s63 offen  lds
    s_add_u32 m0, s67, 11264
    s_add_u32 s63, s72, 2392064
    buffer_load_dwordx4 v4, s[48:51], s63 offen  lds
    s_waitcnt vmcnt(12)
    ds_read_b64_tr_b16 v[144:145], v5 offset:16384
    ds_read_b64_tr_b16 v[146:147], v5 offset:17408
    ds_read_b64_tr_b16 v[148:149], v5 offset:18432
    ds_read_b64_tr_b16 v[150:151], v5 offset:19456
    ds_read_b64_tr_b16 v[152:153], v5 offset:16416
    ds_read_b64_tr_b16 v[154:155], v5 offset:17440
    ds_read_b64_tr_b16 v[156:157], v5 offset:18464
    ds_read_b64_tr_b16 v[158:159], v5 offset:19488
    s_waitcnt lgkmcnt(8)
    s_add_u32 m0, s67, 12288
    s_add_u32 s63, s72, 2621440
    buffer_load_dwordx4 v4, s[48:51], s63 offen  lds
    s_add_u32 m0, s67, 13312
    s_add_u32 s63, s72, 2654208
    buffer_load_dwordx4 v4, s[48:51], s63 offen  lds
    s_add_u32 m0, s67, 14336
    s_add_u32 s63, s72, 2883584
    buffer_load_dwordx4 v4, s[48:51], s63 offen  lds
    s_add_u32 m0, s67, 15360
    s_add_u32 s63, s72, 2916352
    buffer_load_dwordx4 v4, s[48:51], s63 offen  lds
    s_waitcnt vmcnt(12)
    ds_read_b64_tr_b16 v[160:161], v5 offset:0
    ds_read_b64_tr_b16 v[162:163], v5 offset:1024
    ds_read_b64_tr_b16 v[164:165], v5 offset:2048
    ds_read_b64_tr_b16 v[166:167], v5 offset:3072
    ds_read_b64_tr_b16 v[168:169], v5 offset:32
    ds_read_b64_tr_b16 v[170:171], v5 offset:1056
    ds_read_b64_tr_b16 v[172:173], v5 offset:2080
    ds_read_b64_tr_b16 v[174:175], v5 offset:3104
    s_waitcnt lgkmcnt(8)
    s_add_u32 m0, s67, 16384
    s_add_u32 s63, s72, 3145728
    buffer_load_dwordx4 v4, s[48:51], s63 offen  lds
    s_add_u32 m0, s67, 17408
    s_add_u32 s63, s72, 3178496
    buffer_load_dwordx4 v4, s[48:51], s63 offen  lds
    s_add_u32 m0, s67, 18432
    s_add_u32 s63, s72, 3407872
    buffer_load_dwordx4 v4, s[48:51], s63 offen  lds
    s_add_u32 m0, s67, 19456
    s_add_u32 s63, s72, 3440640
    buffer_load_dwordx4 v4, s[48:51], s63 offen  lds
    s_waitcnt vmcnt(12)
    ds_read_b64_tr_b16 v[176:177], v5 offset:4096
    ds_read_b64_tr_b16 v[178:179], v5 offset:5120
    ds_read_b64_tr_b16 v[180:181], v5 offset:6144
    ds_read_b64_tr_b16 v[182:183], v5 offset:7168
    ds_read_b64_tr_b16 v[184:185], v5 offset:4128
    ds_read_b64_tr_b16 v[186:187], v5 offset:5152
    ds_read_b64_tr_b16 v[188:189], v5 offset:6176
    ds_read_b64_tr_b16 v[190:191], v5 offset:7200
    s_waitcnt lgkmcnt(8)
    s_add_u32 m0, s67, 0
    s_add_u32 s63, s72, 3670016
    buffer_load_dwordx4 v4, s[48:51], s63 offen  lds
    s_add_u32 m0, s67, 1024
    s_add_u32 s63, s72, 3702784
    buffer_load_dwordx4 v4, s[48:51], s63 offen  lds
    s_add_u32 m0, s67, 2048
    s_add_u32 s63, s72, 3932160
    buffer_load_dwordx4 v4, s[48:51], s63 offen  lds
    s_add_u32 m0, s67, 3072
    s_add_u32 s63, s72, 3964928
    buffer_load_dwordx4 v4, s[48:51], s63 offen  lds
    s_waitcnt vmcnt(12)
    ds_read_b64_tr_b16 v[192:193], v5 offset:8192
    ds_read_b64_tr_b16 v[194:195], v5 offset:9216
    ds_read_b64_tr_b16 v[196:197], v5 offset:10240
    ds_read_b64_tr_b16 v[198:199], v5 offset:11264
    ds_read_b64_tr_b16 v[200:201], v5 offset:8224
    ds_read_b64_tr_b16 v[202:203], v5 offset:9248
    ds_read_b64_tr_b16 v[204:205], v5 offset:10272
    ds_read_b64_tr_b16 v[206:207], v5 offset:11296
    s_waitcnt lgkmcnt(8)
    s_mov_b32 s44, s20
    s_and_b32 s45, s21, 0xffff
    s_add_u32 m0, s67, 4096
    s_add_u32 s63, s72, 0
    buffer_load_dwordx4 v4, s[44:47], s63 offen  lds
    s_add_u32 m0, s67, 5120
    s_add_u32 s63, s72, 32768
    buffer_load_dwordx4 v4, s[44:47], s63 offen  lds
    s_add_u32 m0, s67, 6144
    s_add_u32 s63, s72, 262144
    buffer_load_dwordx4 v4, s[44:47], s63 offen  lds
    s_add_u32 m0, s67, 7168
    s_add_u32 s63, s72, 294912
    buffer_load_dwordx4 v4, s[44:47], s63 offen  lds
    s_waitcnt vmcnt(12)
    ds_read_b64_tr_b16 v[208:209], v5 offset:12288
    ds_read_b64_tr_b16 v[210:211], v5 offset:13312
    ds_read_b64_tr_b16 v[212:213], v5 offset:14336
    ds_read_b64_tr_b16 v[214:215], v5 offset:15360
    ds_read_b64_tr_b16 v[216:217], v5 offset:12320
    ds_read_b64_tr_b16 v[218:219], v5 offset:13344
    ds_read_b64_tr_b16 v[220:221], v5 offset:14368
    ds_read_b64_tr_b16 v[222:223], v5 offset:15392
    s_waitcnt lgkmcnt(8)
    s_add_u32 m0, s67, 8192
    s_add_u32 s63, s72, 524288
    buffer_load_dwordx4 v4, s[44:47], s63 offen  lds
    s_add_u32 m0, s67, 9216
    s_add_u32 s63, s72, 557056
    buffer_load_dwordx4 v4, s[44:47], s63 offen  lds
    s_add_u32 m0, s67, 10240
    s_add_u32 s63, s72, 786432
    buffer_load_dwordx4 v4, s[44:47], s63 offen  lds
    s_add_u32 m0, s67, 11264
    s_add_u32 s63, s72, 819200
    buffer_load_dwordx4 v4, s[44:47], s63 offen  lds
    s_waitcnt vmcnt(12)
    ds_read_b64_tr_b16 v[224:225], v5 offset:16384
    ds_read_b64_tr_b16 v[226:227], v5 offset:17408
    ds_read_b64_tr_b16 v[228:229], v5 offset:18432
    ds_read_b64_tr_b16 v[230:231], v5 offset:19456
    ds_read_b64_tr_b16 v[232:233], v5 offset:16416
    ds_read_b64_tr_b16 v[234:235], v5 offset:17440
    ds_read_b64_tr_b16 v[236:237], v5 offset:18464
    ds_read_b64_tr_b16 v[238:239], v5 offset:19488
    s_waitcnt lgkmcnt(8)
    s_add_u32 m0, s67, 12288
    s_add_u32 s63, s72, 1048576
    buffer_load_dwordx4 v4, s[44:47], s63 offen  lds
    s_add_u32 m0, s67, 13312
    s_add_u32 s63, s72, 1081344
    buffer_load_dwordx4 v4, s[44:47], s63 offen  lds
    s_add_u32 m0, s67, 14336
    s_add_u32 s63, s72, 1310720
    buffer_load_dwordx4 v4, s[44:47], s63 offen  lds
    s_add_u32 m0, s67, 15360
    s_add_u32 s63, s72, 1343488
    buffer_load_dwordx4 v4, s[44:47], s63 offen  lds
    s_waitcnt vmcnt(12)
    ds_read_b64_tr_b16 v[240:241], v5 offset:0
    ds_read_b64_tr_b16 v[242:243], v5 offset:1024
    ds_read_b64_tr_b16 v[244:245], v5 offset:2048
    ds_read_b64_tr_b16 v[246:247], v5 offset:3072
    ds_read_b64_tr_b16 v[248:249], v5 offset:32
    ds_read_b64_tr_b16 v[250:251], v5 offset:1056
    ds_read_b64_tr_b16 v[252:253], v5 offset:2080
    ds_read_b64_tr_b16 v[254:255], v5 offset:3104
    s_waitcnt lgkmcnt(8)
    s_add_u32 m0, s67, 16384
    s_add_u32 s63, s72, 1572864
    buffer_load_dwordx4 v4, s[44:47], s63 offen  lds
    s_add_u32 m0, s67, 17408
    s_add_u32 s63, s72, 1605632
    buffer_load_dwordx4 v4, s[44:47], s63 offen  lds
    s_add_u32 m0, s67, 18432
    s_add_u32 s63, s72, 1835008
    buffer_load_dwordx4 v4, s[44:47], s63 offen  lds
    s_add_u32 m0, s67, 19456
    s_add_u32 s63, s72, 1867776
    buffer_load_dwordx4 v4, s[44:47], s63 offen  lds
    s_waitcnt vmcnt(12)
    ds_read_b64_tr_b16 a[0:1], v5 offset:4096
    ds_read_b64_tr_b16 a[2:3], v5 offset:5120
    ds_read_b64_tr_b16 a[4:5], v5 offset:6144
    ds_read_b64_tr_b16 a[6:7], v5 offset:7168
    ds_read_b64_tr_b16 a[8:9], v5 offset:4128
    ds_read_b64_tr_b16 a[10:11], v5 offset:5152
    ds_read_b64_tr_b16 a[12:13], v5 offset:6176
    ds_read_b64_tr_b16 a[14:15], v5 offset:7200
    s_waitcnt lgkmcnt(8)
    s_add_u32 m0, s67, 0
    s_add_u32 s63, s72, 2097152
    buffer_load_dwordx4 v4, s[44:47], s63 offen  lds
    s_add_u32 m0, s67, 1024
    s_add_u32 s63, s72, 2129920
    buffer_load_dwordx4 v4, s[44:47], s63 offen  lds
    s_add_u32 m0, s67, 2048
    s_add_u32 s63, s72, 2359296
    buffer_load_dwordx4 v4, s[44:47], s63 offen  lds
    s_add_u32 m0, s67, 3072
    s_add_u32 s63, s72, 2392064
    buffer_load_dwordx4 v4, s[44:47], s63 offen  lds
    s_waitcnt vmcnt(12)
    ds_read_b64_tr_b16 a[16:17], v5 offset:8192
    ds_read_b64_tr_b16 a[18:19], v5 offset:9216
    ds_read_b64_tr_b16 a[20:21], v5 offset:10240
    ds_read_b64_tr_b16 a[22:23], v5 offset:11264
    ds_read_b64_tr_b16 a[24:25], v5 offset:8224
    ds_read_b64_tr_b16 a[26:27], v5 offset:9248
    ds_read_b64_tr_b16 a[28:29], v5 offset:10272
    ds_read_b64_tr_b16 a[30:31], v5 offset:11296
    s_waitcnt lgkmcnt(8)
    s_add_u32 m0, s67, 4096
    s_add_u32 s63, s72, 2621440
    buffer_load_dwordx4 v4, s[44:47], s63 offen  lds
    s_add_u32 m0, s67, 5120
    s_add_u32 s63, s72, 2654208
    buffer_load_dwordx4 v4, s[44:47], s63 offen  lds
    s_add_u32 m0, s67, 6144
    s_add_u32 s63, s72, 2883584
    buffer_load_dwordx4 v4, s[44:47], s63 offen  lds
    s_add_u32 m0, s67, 7168
    s_add_u32 s63, s72, 2916352
    buffer_load_dwordx4 v4, s[44:47], s63 offen  lds
    s_waitcnt vmcnt(12)
    ds_read_b64_tr_b16 a[32:33], v5 offset:12288
    ds_read_b64_tr_b16 a[34:35], v5 offset:13312
    ds_read_b64_tr_b16 a[36:37], v5 offset:14336
    ds_read_b64_tr_b16 a[38:39], v5 offset:15360
    ds_read_b64_tr_b16 a[40:41], v5 offset:12320
    ds_read_b64_tr_b16 a[42:43], v5 offset:13344
    ds_read_b64_tr_b16 a[44:45], v5 offset:14368
    ds_read_b64_tr_b16 a[46:47], v5 offset:15392
    s_waitcnt lgkmcnt(8)
    s_add_u32 m0, s67, 8192
    s_add_u32 s63, s72, 3145728
    buffer_load_dwordx4 v4, s[44:47], s63 offen  lds
    s_add_u32 m0, s67, 9216
    s_add_u32 s63, s72, 3178496
    buffer_load_dwordx4 v4, s[44:47], s63 offen  lds
    s_add_u32 m0, s67, 10240
    s_add_u32 s63, s72, 3407872
    buffer_load_dwordx4 v4, s[44:47], s63 offen  lds
    s_add_u32 m0, s67, 11264
    s_add_u32 s63, s72, 3440640
    buffer_load_dwordx4 v4, s[44:47], s63 offen  lds
    s_waitcnt vmcnt(12)
    ds_read_b64_tr_b16 a[48:49], v5 offset:16384
    ds_read_b64_tr_b16 a[50:51], v5 offset:17408
    ds_read_b64_tr_b16 a[52:53], v5 offset:18432
    ds_read_b64_tr_b16 a[54:55], v5 offset:19456
    ds_read_b64_tr_b16 a[56:57], v5 offset:16416
    ds_read_b64_tr_b16 a[58:59], v5 offset:17440
    ds_read_b64_tr_b16 a[60:61], v5 offset:18464
    ds_read_b64_tr_b16 a[62:63], v5 offset:19488
    s_waitcnt lgkmcnt(8)
    s_add_u32 m0, s67, 12288
    s_add_u32 s63, s72, 3670016
    buffer_load_dwordx4 v4, s[44:47], s63 offen  lds
    s_add_u32 m0, s67, 13312
    s_add_u32 s63, s72, 3702784
    buffer_load_dwordx4 v4, s[44:47], s63 offen  lds
    s_add_u32 m0, s67, 14336
    s_add_u32 s63, s72, 3932160
    buffer_load_dwordx4 v4, s[44:47], s63 offen  lds
    s_add_u32 m0, s67, 15360
    s_add_u32 s63, s72, 3964928
    buffer_load_dwordx4 v4, s[44:47], s63 offen  lds
    s_waitcnt vmcnt(12)
    ds_read_b64_tr_b16 a[64:65], v5 offset:0
    ds_read_b64_tr_b16 a[66:67], v5 offset:1024
    ds_read_b64_tr_b16 a[68:69], v5 offset:2048
    ds_read_b64_tr_b16 a[70:71], v5 offset:3072
    ds_read_b64_tr_b16 a[72:73], v5 offset:32
    ds_read_b64_tr_b16 a[74:75], v5 offset:1056
    ds_read_b64_tr_b16 a[76:77], v5 offset:2080
    ds_read_b64_tr_b16 a[78:79], v5 offset:3104
    s_waitcnt vmcnt(8)
    ds_read_b64_tr_b16 a[80:81], v5 offset:4096
    ds_read_b64_tr_b16 a[82:83], v5 offset:5120
    ds_read_b64_tr_b16 a[84:85], v5 offset:6144
    ds_read_b64_tr_b16 a[86:87], v5 offset:7168
    ds_read_b64_tr_b16 a[88:89], v5 offset:4128
    ds_read_b64_tr_b16 a[90:91], v5 offset:5152
    ds_read_b64_tr_b16 a[92:93], v5 offset:6176
    ds_read_b64_tr_b16 a[94:95], v5 offset:7200
    s_waitcnt vmcnt(4)
    ds_read_b64_tr_b16 a[96:97], v5 offset:8192
    ds_read_b64_tr_b16 a[98:99], v5 offset:9216
    ds_read_b64_tr_b16 a[100:101], v5 offset:10240
    ds_read_b64_tr_b16 a[102:103], v5 offset:11264
    ds_read_b64_tr_b16 a[104:105], v5 offset:8224
    ds_read_b64_tr_b16 a[106:107], v5 offset:9248
    ds_read_b64_tr_b16 a[108:109], v5 offset:10272
    ds_read_b64_tr_b16 a[110:111], v5 offset:11296
    s_waitcnt vmcnt(0)
    ds_read_b64_tr_b16 a[112:113], v5 offset:12288
    ds_read_b64_tr_b16 a[114:115], v5 offset:13312
    ds_read_b64_tr_b16 a[116:117], v5 offset:14336
    ds_read_b64_tr_b16 a[118:119], v5 offset:15360
    ds_read_b64_tr_b16 a[120:121], v5 offset:12320
    ds_read_b64_tr_b16 a[122:123], v5 offset:13344
    ds_read_b64_tr_b16 a[124:125], v5 offset:14368
    ds_read_b64_tr_b16 a[126:127], v5 offset:15392
    s_waitcnt lgkmcnt(0)
    s_mov_b32 s68, 0
    s_lshl_b32 s63, s58, 19
    s_lshl_b32 s64, s57, 14
    s_add_u32 s72, s63, s64
    s_lshl_b32 s64, s56, 12
    s_add_u32 s72, s72, s64
    s_lshl_b32 s64, s56, 11
    s_add_u32 s64, s64, 65536
    v_add_u32 v32, s64, v1
    s_branch L_QKV_B
L_QKV:
    s_waitcnt vmcnt(4)
    s_cmp_lg_u32 s68, 1
    s_cbranch_scc1 L_QKV_B
    s_waitcnt vmcnt(0)
L_QKV_B:
    s_barrier
    ds_read_b128 v[112:115], v8 offset:0
    ds_read_b128 v[116:119], v8 offset:16384
    s_sub_u32 s74, s68, 1
    s_min_u32 s63, s68, 1
    s_max_i32 s74, s74, s63
    s_cmp_lg_u32 s56, 0
    s_cbranch_scc1 L_fs_12
    s_lshl_b32 s63, s57, 7
    s_lshl_b32 s64, s58, 2
    s_add_u32 s63, s63, s64
    s_add_u32 s63, s63, 64028672
    v_mov_b32 v30, s74
    buffer_store_dword v30, off, s[36:39], s63 sc1
L_fs_12:
    s_add_u32 s68, s68, 1
    s_add_u32 s69, s69, 6
    s_xor_b32 s71, s71, 0x8000
    s_cmp_ge_u32 s68, s70
    s_cbranch_scc1 L_QKV_NOX
    s_lshl_b32 s64, s69, 15
    s_lshl_b32 s65, s56, 13
    s_add_u32 s64, s64, s65
    s_add_u32 s65, s65, s71
    s_bitcmp1_b32 s56, 0
    s_cbranch_scc1 L_xo_13
    s_add_u32 m0, s65, 0
    s_add_u32 s63, s64, 0
    buffer_load_dwordx4 v12, s[52:55], s63 offen offset:0 lds
    buffer_load_dwordx4 v13, s[52:55], s63 offen offset:1024 lds
    buffer_load_dwordx4 v14, s[52:55], s63 offen offset:2048 lds
    buffer_load_dwordx4 v15, s[52:55], s63 offen offset:3072 lds
    s_add_u32 m0, s65, 4096
    s_add_u32 s63, s64, 4096
    buffer_load_dwordx4 v16, s[52:55], s63 offen offset:0 lds
    buffer_load_dwordx4 v17, s[52:55], s63 offen offset:1024 lds
    buffer_load_dwordx4 v18, s[52:55], s63 offen offset:2048 lds
    buffer_load_dwordx4 v19, s[52:55], s63 offen offset:3072 lds
    s_branch L_xd_14
L_xo_13:
    s_add_u32 m0, s65, 0
    s_add_u32 s63, s64, 0
    buffer_load_dwordx4 v20, s[52:55], s63 offen offset:0 lds
    buffer_load_dwordx4 v21, s[52:55], s63 offen offset:1024 lds
    buffer_load_dwordx4 v22, s[52:55], s63 offen offset:2048 lds
    buffer_load_dwordx4 v23, s[52:55], s63 offen offset:3072 lds
    s_add_u32 m0, s65, 4096
    s_add_u32 s63, s64, 4096
    buffer_load_dwordx4 v24, s[52:55], s63 offen offset:0 lds
    buffer_load_dwordx4 v25, s[52:55], s63 offen offset:1024 lds
    buffer_load_dwordx4 v26, s[52:55], s63 offen offset:2048 lds
    buffer_load_dwordx4 v27, s[52:55], s63 offen offset:3072 lds
L_xd_14:
L_QKV_NOX:
    s_waitcnt lgkmcnt(0)
    ds_read_b128 v[120:123], v9 offset:0
    ds_read_b128 v[124:127], v9 offset:16384
    v_mfma_f32_16x16x32_bf16 v[80:83], a[128:131], v[112:115], 0
    v_mfma_f32_16x16x32_bf16 v[84:87], a[128:131], v[116:119], 0
    v_mfma_f32_16x16x32_bf16 v[88:91], a[136:139], v[112:115], 0
    v_mfma_f32_16x16x32_bf16 v[92:95], a[136:139], v[116:119], 0
    v_mfma_f32_16x16x32_bf16 v[96:99], v[112:115], v[128:131], 0
    v_mfma_f32_16x16x32_bf16 v[100:103], v[116:119], v[128:131], 0
    v_mfma_f32_16x16x32_bf16 v[104:107], v[112:115], v[136:139], 0
    v_mfma_f32_16x16x32_bf16 v[108:111], v[116:119], v[136:139], 0
    v_mfma_f32_16x16x32_bf16 v[64:67], a[0:3], v[112:115], 0
    v_mfma_f32_16x16x32_bf16 v[68:71], a[0:3], v[116:119], 0
    v_mfma_f32_16x16x32_bf16 v[72:75], a[8:11], v[112:115], 0
    v_mfma_f32_16x16x32_bf16 v[76:79], a[8:11], v[116:119], 0
    s_waitcnt lgkmcnt(0)
    ds_read_b128 v[112:115], v10 offset:0
    ds_read_b128 v[116:119], v10 offset:16384
    v_mfma_f32_16x16x32_bf16 v[80:83], a[132:135], v[120:123], v[80:83]
    v_mfma_f32_16x16x32_bf16 v[84:87], a[132:135], v[124:127], v[84:87]
    v_mfma_f32_16x16x32_bf16 v[88:91], a[140:143], v[120:123], v[88:91]
    v_mfma_f32_16x16x32_bf16 v[92:95], a[140:143], v[124:127], v[92:95]
    v_mfma_f32_16x16x32_bf16 v[96:99], v[120:123], v[132:135], v[96:99]
    v_mfma_f32_16x16x32_bf16 v[100:103], v[124:127], v[132:135], v[100:103]
    v_mfma_f32_16x16x32_bf16 v[104:107], v[120:123], v[140:143], v[104:107]
    v_mfma_f32_16x16x32_bf16 v[108:111], v[124:127], v[140:143], v[108:111]
    v_mfma_f32_16x16x32_bf16 v[64:67], a[4:7], v[120:123], v[64:67]
    v_mfma_f32_16x16x32_bf16 v[68:71], a[4:7], v[124:127], v[68:71]
    v_mfma_f32_16x16x32_bf16 v[72:75], a[12:15], v[120:123], v[72:75]
    v_mfma_f32_16x16x32_bf16 v[76:79], a[12:15], v[124:127], v[76:79]
    s_waitcnt lgkmcnt(0)
    ds_read_b128 v[120:123], v11 offset:0
    ds_read_b128 v[124:127], v11 offset:16384
    v_mfma_f32_16x16x32_bf16 v[80:83], a[144:147], v[112:115], v[80:83]
    v_mfma_f32_16x16x32_bf16 v[84:87], a[144:147], v[116:119], v[84:87]
    v_mfma_f32_16x16x32_bf16 v[88:91], a[152:155], v[112:115], v[88:91]
    v_mfma_f32_16x16x32_bf16 v[92:95], a[152:155], v[116:119], v[92:95]
    v_mfma_f32_16x16x32_bf16 v[96:99], v[112:115], v[144:147], v[96:99]
    v_mfma_f32_16x16x32_bf16 v[100:103], v[116:119], v[144:147], v[100:103]
    v_mfma_f32_16x16x32_bf16 v[104:107], v[112:115], v[152:155], v[104:107]
    v_mfma_f32_16x16x32_bf16 v[108:111], v[116:119], v[152:155], v[108:111]
    v_mfma_f32_16x16x32_bf16 v[64:67], a[16:19], v[112:115], v[64:67]
    v_mfma_f32_16x16x32_bf16 v[68:71], a[16:19], v[116:119], v[68:71]
    v_mfma_f32_16x16x32_bf16 v[72:75], a[24:27], v[112:115], v[72:75]
    v_mfma_f32_16x16x32_bf16 v[76:79], a[24:27], v[116:119], v[76:79]
    s_waitcnt lgkmcnt(0)
    ds_read_b128 v[112:115], v8 offset:256
    ds_read_b128 v[116:119], v8 offset:16640
    v_mfma_f32_16x16x32_bf16 v[80:83], a[148:151], v[120:123], v[80:83]
    v_mfma_f32_16x16x32_bf16 v[84:87], a[148:151], v[124:127], v[84:87]
    v_mfma_f32_16x16x32_bf16 v[88:91], a[156:159], v[120:123], v[88:91]
    v_mfma_f32_16x16x32_bf16 v[92:95], a[156:159], v[124:127], v[92:95]
    v_mfma_f32_16x16x32_bf16 v[96:99], v[120:123], v[148:151], v[96:99]
    v_mfma_f32_16x16x32_bf16 v[100:103], v[124:127], v[148:151], v[100:103]
    v_mfma_f32_16x16x32_bf16 v[104:107], v[120:123], v[156:159], v[104:107]
    v_mfma_f32_16x16x32_bf16 v[108:111], v[124:127], v[156:159], v[108:111]
    v_mfma_f32_16x16x32_bf16 v[64:67], a[20:23], v[120:123], v[64:67]
    v_mfma_f32_16x16x32_bf16 v[68:71], a[20:23], v[124:127], v[68:71]
    v_mfma_f32_16x16x32_bf16 v[72:75], a[28:31], v[120:123], v[72:75]
    v_mfma_f32_16x16x32_bf16 v[76:79], a[28:31], v[124:127], v[76:79]
    s_waitcnt lgkmcnt(0)
    ds_read_b128 v[120:123], v9 offset:256
    ds_read_b128 v[124:127], v9 offset:16640
    v_mfma_f32_16x16x32_bf16 v[80:83], a[160:163], v[112:115], v[80:83]
    v_mfma_f32_16x16x32_bf16 v[84:87], a[160:163], v[116:119], v[84:87]
    v_mfma_f32_16x16x32_bf16 v[88:91], a[168:171], v[112:115], v[88:91]
    v_mfma_f32_16x16x32_bf16 v[92:95], a[168:171], v[116:119], v[92:95]
    v_mfma_f32_16x16x32_bf16 v[96:99], v[112:115], v[160:163], v[96:99]
    v_mfma_f32_16x16x32_bf16 v[100:103], v[116:119], v[160:163], v[100:103]
    v_mfma_f32_16x16x32_bf16 v[104:107], v[112:115], v[168:171], v[104:107]
    v_mfma_f32_16x16x32_bf16 v[108:111], v[116:119], v[168:171], v[108:111]
    v_mfma_f32_16x16x32_bf16 v[64:67], a[32:35], v[112:115], v[64:67]
    v_mfma_f32_16x16x32_bf16 v[68:71], a[32:35], v[116:119], v[68:71]
    v_mfma_f32_16x16x32_bf16 v[72:75], a[40:43], v[112:115], v[72:75]
    v_mfma_f32_16x16x32_bf16 v[76:79], a[40:43], v[116:119], v[76:79]
    s_waitcnt lgkmcnt(0)
    ds_read_b128 v[112:115], v10 offset:256
    ds_read_b128 v[116:119], v10 offset:16640
    v_mfma_f32_16x16x32_bf16 v[80:83], a[164:167], v[120:123], v[80:83]
    v_mfma_f32_16x16x32_bf16 v[84:87], a[164:167], v[124:127], v[84:87]
    v_mfma_f32_16x16x32_bf16 v[88:91], a[172:175], v[120:123], v[88:91]
    v_mfma_f32_16x16x32_bf16 v[92:95], a[172:175], v[124:127], v[92:95]
    v_mfma_f32_16x16x32_bf16 v[96:99], v[120:123], v[164:167], v[96:99]
    v_mfma_f32_16x16x32_bf16 v[100:103], v[124:127], v[164:167], v[100:103]
    v_mfma_f32_16x16x32_bf16 v[104:107], v[120:123], v[172:175], v[104:107]
    v_mfma_f32_16x16x32_bf16 v[108:111], v[124:127], v[172:175], v[108:111]
    v_mfma_f32_16x16x32_bf16 v[64:67], a[36:39], v[120:123], v[64:67]
    v_mfma_f32_16x16x32_bf16 v[68:71], a[36:39], v[124:127], v[68:71]
    v_mfma_f32_16x16x32_bf16 v[72:75], a[44:47], v[120:123], v[72:75]
    v_mfma_f32_16x16x32_bf16 v[76:79], a[44:47], v[124:127], v[76:79]
    s_waitcnt lgkmcnt(0)
    ds_read_b128 v[120:123], v11 offset:256
    ds_read_b128 v[124:127], v11 offset:16640
    v_mfma_f32_16x16x32_bf16 v[80:83], a[176:179], v[112:115], v[80:83]
    v_mfma_f32_16x16x32_bf16 v[84:87], a[176:179], v[116:119], v[84:87]
    v_mfma_f32_16x16x32_bf16 v[88:91], a[184:187], v[112:115], v[88:91]
    v_mfma_f32_16x16x32_bf16 v[92:95], a[184:187], v[116:119], v[92:95]
    v_mfma_f32_16x16x32_bf16 v[96:99], v[112:115], v[176:179], v[96:99]
    v_mfma_f32_16x16x32_bf16 v[100:103], v[116:119], v[176:179], v[100:103]
    v_mfma_f32_16x16x32_bf16 v[104:107], v[112:115], v[184:187], v[104:107]
    v_mfma_f32_16x16x32_bf16 v[108:111], v[116:119], v[184:187], v[108:111]
    v_mfma_f32_16x16x32_bf16 v[64:67], a[48:51], v[112:115], v[64:67]
    v_mfma_f32_16x16x32_bf16 v[68:71], a[48:51], v[116:119], v[68:71]
    v_mfma_f32_16x16x32_bf16 v[72:75], a[56:59], v[112:115], v[72:75]
    v_mfma_f32_16x16x32_bf16 v[76:79], a[56:59], v[116:119], v[76:79]
    s_waitcnt lgkmcnt(0)
    ds_read_b128 v[112:115], v8 offset:512
    ds_read_b128 v[116:119], v8 offset:16896
    v_mfma_f32_16x16x32_bf16 v[80:83], a[180:183], v[120:123], v[80:83]
    v_mfma_f32_16x16x32_bf16 v[84:87], a[180:183], v[124:127], v[84:87]
    v_mfma_f32_16x16x32_bf16 v[88:91], a[188:191], v[120:123], v[88:91]
    v_mfma_f32_16x16x32_bf16 v[92:95], a[188:191], v[124:127], v[92:95]
    v_mfma_f32_16x16x32_bf16 v[96:99], v[120:123], v[180:183], v[96:99]
    v_mfma_f32_16x16x32_bf16 v[100:103], v[124:127], v[180:183], v[100:103]
    v_mfma_f32_16x16x32_bf16 v[104:107], v[120:123], v[188:191], v[104:107]
    v_mfma_f32_16x16x32_bf16 v[108:111], v[124:127], v[188:191], v[108:111]
    v_mfma_f32_16x16x32_bf16 v[64:67], a[52:55], v[120:123], v[64:67]
    v_mfma_f32_16x16x32_bf16 v[68:71], a[52:55], v[124:127], v[68:71]
    v_mfma_f32_16x16x32_bf16 v[72:75], a[60:63], v[120:123], v[72:75]
    v_mfma_f32_16x16x32_bf16 v[76:79], a[60:63], v[124:127], v[76:79]
    s_waitcnt lgkmcnt(0)
    ds_read_b128 v[120:123], v9 offset:512
    ds_read_b128 v[124:127], v9 offset:16896
    v_mfma_f32_16x16x32_bf16 v[80:83], a[192:195], v[112:115], v[80:83]
    v_mfma_f32_16x16x32_bf16 v[84:87], a[192:195], v[116:119], v[84:87]
    v_mfma_f32_16x16x32_bf16 v[88:91], a[200:203], v[112:115], v[88:91]
    v_mfma_f32_16x16x32_bf16 v[92:95], a[200:203], v[116:119], v[92:95]
    v_mfma_f32_16x16x32_bf16 v[96:99], v[112:115], v[192:195], v[96:99]
    v_mfma_f32_16x16x32_bf16 v[100:103], v[116:119], v[192:195], v[100:103]
    v_mfma_f32_16x16x32_bf16 v[104:107], v[112:115], v[200:203], v[104:107]
    v_mfma_f32_16x16x32_bf16 v[108:111], v[116:119], v[200:203], v[108:111]
    v_mfma_f32_16x16x32_bf16 v[64:67], a[64:67], v[112:115], v[64:67]
    v_mfma_f32_16x16x32_bf16 v[68:71], a[64:67], v[116:119], v[68:71]
    v_mfma_f32_16x16x32_bf16 v[72:75], a[72:75], v[112:115], v[72:75]
    v_mfma_f32_16x16x32_bf16 v[76:79], a[72:75], v[116:119], v[76:79]
    s_waitcnt lgkmcnt(0)
    ds_read_b128 v[112:115], v10 offset:512
    ds_read_b128 v[116:119], v10 offset:16896
    v_mfma_f32_16x16x32_bf16 v[80:83], a[196:199], v[120:123], v[80:83]
    v_mfma_f32_16x16x32_bf16 v[84:87], a[196:199], v[124:127], v[84:87]
    v_mfma_f32_16x16x32_bf16 v[88:91], a[204:207], v[120:123], v[88:91]
    v_mfma_f32_16x16x32_bf16 v[92:95], a[204:207], v[124:127], v[92:95]
    v_mfma_f32_16x16x32_bf16 v[96:99], v[120:123], v[196:199], v[96:99]
    v_mfma_f32_16x16x32_bf16 v[100:103], v[124:127], v[196:199], v[100:103]
    v_mfma_f32_16x16x32_bf16 v[104:107], v[120:123], v[204:207], v[104:107]
    v_mfma_f32_16x16x32_bf16 v[108:111], v[124:127], v[204:207], v[108:111]
    v_mfma_f32_16x16x32_bf16 v[64:67], a[68:71], v[120:123], v[64:67]
    v_mfma_f32_16x16x32_bf16 v[68:71], a[68:71], v[124:127], v[68:71]
    v_mfma_f32_16x16x32_bf16 v[72:75], a[76:79], v[120:123], v[72:75]
    v_mfma_f32_16x16x32_bf16 v[76:79], a[76:79], v[124:127], v[76:79]
    s_waitcnt lgkmcnt(0)
    ds_read_b128 v[120:123], v11 offset:512
    ds_read_b128 v[124:127], v11 offset:16896
    v_mfma_f32_16x16x32_bf16 v[80:83], a[208:211], v[112:115], v[80:83]
    v_mfma_f32_16x16x32_bf16 v[84:87], a[208:211], v[116:119], v[84:87]
    v_mfma_f32_16x16x32_bf16 v[88:91], a[216:219], v[112:115], v[88:91]
    v_mfma_f32_16x16x32_bf16 v[92:95], a[216:219], v[116:119], v[92:95]
    v_mfma_f32_16x16x32_bf16 v[96:99], v[112:115], v[208:211], v[96:99]
    v_mfma_f32_16x16x32_bf16 v[100:103], v[116:119], v[208:211], v[100:103]
    v_mfma_f32_16x16x32_bf16 v[104:107], v[112:115], v[216:219], v[104:107]
    v_mfma_f32_16x16x32_bf16 v[108:111], v[116:119], v[216:219], v[108:111]
    v_mfma_f32_16x16x32_bf16 v[64:67], a[80:83], v[112:115], v[64:67]
    v_mfma_f32_16x16x32_bf16 v[68:71], a[80:83], v[116:119], v[68:71]
    v_mfma_f32_16x16x32_bf16 v[72:75], a[88:91], v[112:115], v[72:75]
    v_mfma_f32_16x16x32_bf16 v[76:79], a[88:91], v[116:119], v[76:79]
    s_waitcnt lgkmcnt(0)
    ds_read_b128 v[112:115], v8 offset:768
    ds_read_b128 v[116:119], v8 offset:17152
    v_mfma_f32_16x16x32_bf16 v[80:83], a[212:215], v[120:123], v[80:83]
    v_mfma_f32_16x16x32_bf16 v[84:87], a[212:215], v[124:127], v[84:87]
    v_mfma_f32_16x16x32_bf16 v[88:91], a[220:223], v[120:123], v[88:91]
    v_mfma_f32_16x16x32_bf16 v[92:95], a[220:223], v[124:127], v[92:95]
    v_mfma_f32_16x16x32_bf16 v[96:99], v[120:123], v[212:215], v[96:99]
    v_mfma_f32_16x16x32_bf16 v[100:103], v[124:127], v[212:215], v[100:103]
    v_mfma_f32_16x16x32_bf16 v[104:107], v[120:123], v[220:223], v[104:107]
    v_mfma_f32_16x16x32_bf16 v[108:111], v[124:127], v[220:223], v[108:111]
    v_mfma_f32_16x16x32_bf16 v[64:67], a[84:87], v[120:123], v[64:67]
    v_mfma_f32_16x16x32_bf16 v[68:71], a[84:87], v[124:127], v[68:71]
    v_mfma_f32_16x16x32_bf16 v[72:75], a[92:95], v[120:123], v[72:75]
    v_mfma_f32_16x16x32_bf16 v[76:79], a[92:95], v[124:127], v[76:79]
    s_waitcnt lgkmcnt(0)
    ds_read_b128 v[120:123], v9 offset:768
    ds_read_b128 v[124:127], v9 offset:17152
    v_mfma_f32_16x16x32_bf16 v[80:83], a[224:227], v[112:115], v[80:83]
    v_mfma_f32_16x16x32_bf16 v[84:87], a[224:227], v[116:119], v[84:87]
    v_mfma_f32_16x16x32_bf16 v[88:91], a[232:235], v[112:115], v[88:91]
    v_mfma_f32_16x16x32_bf16 v[92:95], a[232:235], v[116:119], v[92:95]
    v_mfma_f32_16x16x32_bf16 v[96:99], v[112:115], v[224:227], v[96:99]
    v_mfma_f32_16x16x32_bf16 v[100:103], v[116:119], v[224:227], v[100:103]
    v_mfma_f32_16x16x32_bf16 v[104:107], v[112:115], v[232:235], v[104:107]
    v_mfma_f32_16x16x32_bf16 v[108:111], v[116:119], v[232:235], v[108:111]
    v_mfma_f32_16x16x32_bf16 v[64:67], a[96:99], v[112:115], v[64:67]
    v_mfma_f32_16x16x32_bf16 v[68:71], a[96:99], v[116:119], v[68:71]
    v_mfma_f32_16x16x32_bf16 v[72:75], a[104:107], v[112:115], v[72:75]
    v_mfma_f32_16x16x32_bf16 v[76:79], a[104:107], v[116:119], v[76:79]
    s_waitcnt lgkmcnt(0)
    ds_read_b128 v[112:115], v10 offset:768
    ds_read_b128 v[116:119], v10 offset:17152
    v_mfma_f32_16x16x32_bf16 v[80:83], a[228:231], v[120:123], v[80:83]
    v_mfma_f32_16x16x32_bf16 v[84:87], a[228:231], v[124:127], v[84:87]
    v_mfma_f32_16x16x32_bf16 v[88:91], a[236:239], v[120:123], v[88:91]
    v_mfma_f32_16x16x32_bf16 v[92:95], a[236:239], v[124:127], v[92:95]
    v_mfma_f32_16x16x32_bf16 v[96:99], v[120:123], v[228:231], v[96:99]
    v_mfma_f32_16x16x32_bf16 v[100:103], v[124:127], v[228:231], v[100:103]
    v_mfma_f32_16x16x32_bf16 v[104:107], v[120:123], v[236:239], v[104:107]
    v_mfma_f32_16x16x32_bf16 v[108:111], v[124:127], v[236:239], v[108:111]
    v_mfma_f32_16x16x32_bf16 v[64:67], a[100:103], v[120:123], v[64:67]
    v_mfma_f32_16x16x32_bf16 v[68:71], a[100:103], v[124:127], v[68:71]
    v_mfma_f32_16x16x32_bf16 v[72:75], a[108:111], v[120:123], v[72:75]
    v_mfma_f32_16x16x32_bf16 v[76:79], a[108:111], v[124:127], v[76:79]
    s_waitcnt lgkmcnt(0)
    ds_read_b128 v[120:123], v11 offset:768
    ds_read_b128 v[124:127], v11 offset:17152
    v_mfma_f32_16x16x32_bf16 v[80:83], a[240:243], v[112:115], v[80:83]
    v_mfma_f32_16x16x32_bf16 v[84:87], a[240:243], v[116:119], v[84:87]
    v_mfma_f32_16x16x32_bf16 v[88:91], a[248:251], v[112:115], v[88:91]
    v_mfma_f32_16x16x32_bf16 v[92:95], a[248:251], v[116:119], v[92:95]
    v_mfma_f32_16x16x32_bf16 v[96:99], v[112:115], v[240:243], v[96:99]
    v_mfma_f32_16x16x32_bf16 v[100:103], v[116:119], v[240:243], v[100:103]
    v_mfma_f32_16x16x32_bf16 v[104:107], v[112:115], v[248:251], v[104:107]
    v_mfma_f32_16x16x32_bf16 v[108:111], v[116:119], v[248:251], v[108:111]
    v_mfma_f32_16x16x32_bf16 v[64:67], a[112:115], v[112:115], v[64:67]
    v_mfma_f32_16x16x32_bf16 v[68:71], a[112:115], v[116:119], v[68:71]
    v_mfma_f32_16x16x32_bf16 v[72:75], a[120:123], v[112:115], v[72:75]
    v_mfma_f32_16x16x32_bf16 v[76:79], a[120:123], v[116:119], v[76:79]
    s_waitcnt lgkmcnt(0)
    v_mfma_f32_16x16x32_bf16 v[80:83], a[244:247], v[120:123], v[80:83]
    v_mfma_f32_16x16x32_bf16 v[84:87], a[244:247], v[124:127], v[84:87]
    v_mfma_f32_16x16x32_bf16 v[88:91], a[252:255], v[120:123], v[88:91]
    v_mfma_f32_16x16x32_bf16 v[92:95], a[252:255], v[124:127], v[92:95]
    v_mfma_f32_16x16x32_bf16 v[96:99], v[120:123], v[244:247], v[96:99]
    v_mfma_f32_16x16x32_bf16 v[100:103], v[124:127], v[244:247], v[100:103]
    v_mfma_f32_16x16x32_bf16 v[104:107], v[120:123], v[252:255], v[104:107]
    v_mfma_f32_16x16x32_bf16 v[108:111], v[124:127], v[252:255], v[108:111]
    v_mfma_f32_16x16x32_bf16 v[64:67], a[116:119], v[120:123], v[64:67]
    v_mfma_f32_16x16x32_bf16 v[68:71], a[116:119], v[124:127], v[68:71]
    v_mfma_f32_16x16x32_bf16 v[72:75], a[124:127], v[120:123], v[72:75]
    v_mfma_f32_16x16x32_bf16 v[76:79], a[124:127], v[124:127], v[76:79]
    v_xor_b32 v8, 0x8000, v8
    v_xor_b32 v9, 0x8000, v9
    v_xor_b32 v10, 0x8000, v10
    v_xor_b32 v11, 0x8000, v11
    v_mul_f32 v80, 0x3e0293ee, v80
    v_mul_f32 v81, 0x3e0293ee, v81
    v_mul_f32 v82, 0x3e0293ee, v82
    v_mul_f32 v83, 0x3e0293ee, v83
    v_cvt_pk_bf16_f32 v36, v80, v81
    v_cvt_pk_bf16_f32 v37, v82, v83
    v_mul_f32 v88, 0x3e0293ee, v88
    v_mul_f32 v89, 0x3e0293ee, v89
    v_mul_f32 v90, 0x3e0293ee, v90
    v_mul_f32 v91, 0x3e0293ee, v91
    v_cvt_pk_bf16_f32 v38, v88, v89
    v_cvt_pk_bf16_f32 v39, v90, v91
    buffer_store_dwordx4 v[36:39], v1, s[36:39], s72 offen offset:0 sc1
    v_mul_f32 v84, 0x3e0293ee, v84
    v_mul_f32 v85, 0x3e0293ee, v85
    v_mul_f32 v86, 0x3e0293ee, v86
    v_mul_f32 v87, 0x3e0293ee, v87
    v_cvt_pk_bf16_f32 v40, v84, v85
    v_cvt_pk_bf16_f32 v41, v86, v87
    v_mul_f32 v92, 0x3e0293ee, v92
    v_mul_f32 v93, 0x3e0293ee, v93
    v_mul_f32 v94, 0x3e0293ee, v94
    v_mul_f32 v95, 0x3e0293ee, v95
    v_cvt_pk_bf16_f32 v42, v92, v93
    v_cvt_pk_bf16_f32 v43, v94, v95
    buffer_store_dwordx4 v[40:43], v1, s[36:39], s72 offen offset:1024 sc1
    v_cvt_pk_bf16_f32 v44, v96, v97
    v_cvt_pk_bf16_f32 v45, v98, v99
    v_cvt_pk_bf16_f32 v46, v100, v101
    v_cvt_pk_bf16_f32 v47, v102, v103
    buffer_store_dwordx4 v[44:47], v1, s[36:39], s72 offen offset:2048 sc1
    v_cvt_pk_bf16_f32 v48, v104, v105
    v_cvt_pk_bf16_f32 v49, v106, v107
    v_cvt_pk_bf16_f32 v50, v108, v109
    v_cvt_pk_bf16_f32 v51, v110, v111
    buffer_store_dwordx4 v[48:51], v1, s[36:39], s72 offen offset:3072 sc1
    v_cvt_pk_bf16_f32 v52, v64, v65
    v_cvt_pk_bf16_f32 v53, v66, v67
    v_cvt_pk_bf16_f32 v54, v72, v73
    v_cvt_pk_bf16_f32 v55, v74, v75
    ds_write_b128 v32, v[52:55] offset:0
    v_cvt_pk_bf16_f32 v56, v68, v69
    v_cvt_pk_bf16_f32 v57, v70, v71
    v_cvt_pk_bf16_f32 v58, v76, v77
    v_cvt_pk_bf16_f32 v59, v78, v79
    ds_write_b128 v32, v[56:59] offset:1024
    v_add_u32 v32, 8192, v32
    s_add_u32 s72, s72, 3145728
    s_cmp_lt_u32 s68, s70
    s_cbranch_scc1 L_QKV
    s_waitcnt vmcnt(0) lgkmcnt(0)
    s_barrier
    s_cmp_lg_u32 s56, 0
    s_cbranch_scc1 L_fs_15
    s_lshl_b32 s63, s57, 7
    s_lshl_b32 s64, s58, 2
    s_add_u32 s63, s63, s64
    s_add_u32 s63, s63, 64028672
    v_mov_b32 v30, 100
    buffer_store_dword v30, off, s[36:39], s63 sc1
L_fs_15:
    s_mov_b32 s44, s10
    s_and_b32 s45, s11, 0xffff
    s_mov_b32 s46, 1572864
    s_mov_b32 s47, 0x20000
    s_mov_b32 s48, s12
    s_and_b32 s49, s13, 0xffff
    s_mov_b32 s50, 16384
    s_mov_b32 s51, 0x20000
    s_mov_b32 s52, s8
    s_and_b32 s53, s9, 0xffff
    s_mov_b32 s54, 2097152
    s_mov_b32 s55, 0x20000
    v_bfe_u32 v30, v0, 2, 2
    v_lshl_add_u32 v30, v2, 3, v30
    v_mul_u32_u24 v30, 3072, v30
    v_and_b32 v31, 1, v0
    v_lshl_add_u32 v30, v31, 4, v30
    v_bfe_u32 v31, v0, 1, 1
    v_lshl_add_u32 v32, v31, 10, v30
    v_mul_u32_u24 v31, 786432, v31
    v_add_u32 v33, v31, v30
    s_lshl_b32 s72, s57, 5
    s_mul_i32 s64, s56, 196608
    s_add_u32 s72, s72, s64
    s_lshl_b32 s65, s56, 12
    s_add_u32 s65, s65, 0
    s_add_u32 m0, s65, 0
    s_add_u32 s63, s72, 0
    buffer_load_dwordx4 v32, s[44:47], s63 offen lds
    s_add_u32 m0, s65, 1024
    s_add_u32 s63, s72, 12288
    buffer_load_dwordx4 v32, s[44:47], s63 offen lds
    s_add_u32 m0, s65, 2048
    s_add_u32 s63, s72, 98304
    buffer_load_dwordx4 v32, s[44:47], s63 offen lds
    s_add_u32 m0, s65, 3072
    s_add_u32 s63, s72, 110592
    buffer_load_dwordx4 v32, s[44:47], s63 offen lds
    s_add_u32 m0, s65, 16384
    s_add_u32 s63, s72, 786432
    buffer_load_dwordx4 v32, s[44:47], s63 offen lds
    s_add_u32 m0, s65, 17408
    s_add_u32 s63, s72, 798720
    buffer_load_dwordx4 v32, s[44:47], s63 offen lds
    s_add_u32 m0, s65, 18432
    s_add_u32 s63, s72, 884736
    buffer_load_dwordx4 v32, s[44:47], s63 offen lds
    s_add_u32 m0, s65, 19456
    s_add_u32 s63, s72, 897024
    buffer_load_dwordx4 v32, s[44:47], s63 offen lds
    s_add_u32 m0, s65, 32768
    s_add_u32 s63, s72, 2048
    buffer_load_dwordx4 v33, s[44:47], s63 offen lds
    s_add_u32 m0, s65, 33792
    s_add_u32 s63, s72, 14336
    buffer_load_dwordx4 v33, s[44:47], s63 offen lds
    s_add_u32 m0, s65, 34816
    s_add_u32 s63, s72, 100352
    buffer_load_dwordx4 v33, s[44:47], s63 offen lds
    s_add_u32 m0, s65, 35840
    s_add_u32 s63, s72, 112640
    buffer_load_dwordx4 v33, s[44:47], s63 offen lds
    v_lshlrev_b32 v30, 7, v2
    v_lshl_add_u32 v30, v3, 1, v30
    s_lshl_b32 s63, s57, 9
    buffer_load_ushort v32, v30, s[48:51], s63 offen
    buffer_load_ushort v33, v30, s[48:51], s63 offen offset:64
    buffer_load_ushort v34, v30, s[48:51], s63 offen offset:32
    buffer_load_ushort v35, v30, s[48:51], s63 offen offset:96
    s_waitcnt vmcnt(0)
    v_lshl_or_b32 v32, v34, 16, v32
    v_lshl_or_b32 v33, v35, 16, v33
    v_subrev_u32 v5, s67, v5
    v_add_u32 v5, 0, v5
    s_barrier
    ds_read_b64_tr_b16 a[0:1], v5 offset:0
    ds_read_b64_tr_b16 a[2:3], v5 offset:1024
    ds_read_b64_tr_b16 a[4:5], v5 offset:2048
    ds_read_b64_tr_b16 a[6:7], v5 offset:3072
    ds_read_b64_tr_b16 a[64:65], v5 offset:32
    ds_read_b64_tr_b16 a[66:67], v5 offset:1056
    ds_read_b64_tr_b16 a[68:69], v5 offset:2080
    ds_read_b64_tr_b16 a[70:71], v5 offset:3104
    s_waitcnt lgkmcnt(8)
    ds_read_b64_tr_b16 a[8:9], v5 offset:4096
    ds_read_b64_tr_b16 a[10:11], v5 offset:5120
    ds_read_b64_tr_b16 a[12:13], v5 offset:6144
    ds_read_b64_tr_b16 a[14:15], v5 offset:7168
    ds_read_b64_tr_b16 a[72:73], v5 offset:4128
    ds_read_b64_tr_b16 a[74:75], v5 offset:5152
    ds_read_b64_tr_b16 a[76:77], v5 offset:6176
    ds_read_b64_tr_b16 a[78:79], v5 offset:7200
    s_waitcnt lgkmcnt(8)
    ds_read_b64_tr_b16 a[16:17], v5 offset:8192
    ds_read_b64_tr_b16 a[18:19], v5 offset:9216
    ds_read_b64_tr_b16 a[20:21], v5 offset:10240
    ds_read_b64_tr_b16 a[22:23], v5 offset:11264
    ds_read_b64_tr_b16 a[80:81], v5 offset:8224
    ds_read_b64_tr_b16 a[82:83], v5 offset:9248
    ds_read_b64_tr_b16 a[84:85], v5 offset:10272
    ds_read_b64_tr_b16 a[86:87], v5 offset:11296
    s_waitcnt lgkmcnt(8)
    ds_read_b64_tr_b16 a[24:25], v5 offset:12288
    ds_read_b64_tr_b16 a[26:27], v5 offset:13312
    ds_read_b64_tr_b16 a[28:29], v5 offset:14336
    ds_read_b64_tr_b16 a[30:31], v5 offset:15360
    ds_read_b64_tr_b16 a[88:89], v5 offset:12320
    ds_read_b64_tr_b16 a[90:91], v5 offset:13344
    ds_read_b64_tr_b16 a[92:93], v5 offset:14368
    ds_read_b64_tr_b16 a[94:95], v5 offset:15392
    s_waitcnt lgkmcnt(8)
    ds_read_b64_tr_b16 a[32:33], v5 offset:16384
    ds_read_b64_tr_b16 a[34:35], v5 offset:17408
    ds_read_b64_tr_b16 a[36:37], v5 offset:18432
    ds_read_b64_tr_b16 a[38:39], v5 offset:19456
    ds_read_b64_tr_b16 a[96:97], v5 offset:16416
    ds_read_b64_tr_b16 a[98:99], v5 offset:17440
    ds_read_b64_tr_b16 a[100:101], v5 offset:18464
    ds_read_b64_tr_b16 a[102:103], v5 offset:19488
    s_waitcnt lgkmcnt(8)
    ds_read_b64_tr_b16 a[40:41], v5 offset:20480
    ds_read_b64_tr_b16 a[42:43], v5 offset:21504
    ds_read_b64_tr_b16 a[44:45], v5 offset:22528
    ds_read_b64_tr_b16 a[46:47], v5 offset:23552
    ds_read_b64_tr_b16 a[104:105], v5 offset:20512
    ds_read_b64_tr_b16 a[106:107], v5 offset:21536
    ds_read_b64_tr_b16 a[108:109], v5 offset:22560
    ds_read_b64_tr_b16 a[110:111], v5 offset:23584
    s_waitcnt lgkmcnt(8)
    ds_read_b64_tr_b16 a[48:49], v5 offset:24576
    ds_read_b64_tr_b16 a[50:51], v5 offset:25600
    ds_read_b64_tr_b16 a[52:53], v5 offset:26624
    ds_read_b64_tr_b16 a[54:55], v5 offset:27648
    ds_read_b64_tr_b16 a[112:113], v5 offset:24608
    ds_read_b64_tr_b16 a[114:115], v5 offset:25632
    ds_read_b64_tr_b16 a[116:117], v5 offset:26656
    ds_read_b64_tr_b16 a[118:119], v5 offset:27680
    s_waitcnt lgkmcnt(8)
    ds_read_b64_tr_b16 a[56:57], v5 offset:28672
    ds_read_b64_tr_b16 a[58:59], v5 offset:29696
    ds_read_b64_tr_b16 a[60:61], v5 offset:30720
    ds_read_b64_tr_b16 a[62:63], v5 offset:31744
    ds_read_b64_tr_b16 a[120:121], v5 offset:28704
    ds_read_b64_tr_b16 a[122:123], v5 offset:29728
    ds_read_b64_tr_b16 a[124:125], v5 offset:30752
    ds_read_b64_tr_b16 a[126:127], v5 offset:31776
    s_waitcnt lgkmcnt(8)
    ds_read_b64_tr_b16 a[128:129], v5 offset:32768
    ds_read_b64_tr_b16 a[130:131], v5 offset:33792
    ds_read_b64_tr_b16 a[132:133], v5 offset:34816
    ds_read_b64_tr_b16 a[134:135], v5 offset:35840
    ds_read_b64_tr_b16 a[160:161], v5 offset:32800
    ds_read_b64_tr_b16 a[162:163], v5 offset:33824
    ds_read_b64_tr_b16 a[164:165], v5 offset:34848
    ds_read_b64_tr_b16 a[166:167], v5 offset:35872
    s_waitcnt lgkmcnt(8)
    ds_read_b64_tr_b16 a[136:137], v5 offset:36864
    ds_read_b64_tr_b16 a[138:139], v5 offset:37888
    ds_read_b64_tr_b16 a[140:141], v5 offset:38912
    ds_read_b64_tr_b16 a[142:143], v5 offset:39936
    ds_read_b64_tr_b16 a[168:169], v5 offset:36896
    ds_read_b64_tr_b16 a[170:171], v5 offset:37920
    ds_read_b64_tr_b16 a[172:173], v5 offset:38944
    ds_read_b64_tr_b16 a[174:175], v5 offset:39968
    s_waitcnt lgkmcnt(8)
    ds_read_b64_tr_b16 a[144:145], v5 offset:40960
    ds_read_b64_tr_b16 a[146:147], v5 offset:41984
    ds_read_b64_tr_b16 a[148:149], v5 offset:43008
    ds_read_b64_tr_b16 a[150:151], v5 offset:44032
    ds_read_b64_tr_b16 a[176:177], v5 offset:40992
    ds_read_b64_tr_b16 a[178:179], v5 offset:42016
    ds_read_b64_tr_b16 a[180:181], v5 offset:43040
    ds_read_b64_tr_b16 a[182:183], v5 offset:44064
    s_waitcnt lgkmcnt(8)
    ds_read_b64_tr_b16 a[152:153], v5 offset:45056
    ds_read_b64_tr_b16 a[154:155], v5 offset:46080
    ds_read_b64_tr_b16 a[156:157], v5 offset:47104
    ds_read_b64_tr_b16 a[158:159], v5 offset:48128
    ds_read_b64_tr_b16 a[184:185], v5 offset:45088
    ds_read_b64_tr_b16 a[186:187], v5 offset:46112
    ds_read_b64_tr_b16 a[188:189], v5 offset:47136
    ds_read_b64_tr_b16 a[190:191], v5 offset:48160
    s_waitcnt lgkmcnt(8)
    s_waitcnt vmcnt(0) lgkmcnt(0)
    s_barrier
    s_lshl_b32 s71, s56, 14
    s_add_u32 s71, s71, 0
    s_mul_i32 s76, s56, 6
    s_add_u32 s76, s76, s58
    s_mov_b32 s77, 0x3fb8aa3b
    v_and_b32 v8, 0x3fff, v8
    v_add_u32 v8, s71, v8
    v_and_b32 v9, 0x3fff, v9
    v_add_u32 v9, s71, v9
    v_and_b32 v10, 0x3fff, v10
    v_add_u32 v10, s71, v10
    v_and_b32 v11, 0x3fff, v11
    v_add_u32 v11, s71, v11
    s_lshl_b32 s64, s76, 14
    s_add_u32 m0, s71, 0
    s_add_u32 s63, s64, 0
    buffer_load_dwordx4 v12, s[52:55], s63 offen offset:0 lds
    buffer_load_dwordx4 v13, s[52:55], s63 offen offset:1024 lds
    buffer_load_dwordx4 v14, s[52:55], s63 offen offset:2048 lds
    buffer_load_dwordx4 v15, s[52:55], s63 offen offset:3072 lds
    s_add_u32 m0, s71, 4096
    s_add_u32 s63, s64, 4096
    buffer_load_dwordx4 v16, s[52:55], s63 offen offset:0 lds
    buffer_load_dwordx4 v17, s[52:55], s63 offen offset:1024 lds
    buffer_load_dwordx4 v18, s[52:55], s63 offen offset:2048 lds
    buffer_load_dwordx4 v19, s[52:55], s63 offen offset:3072 lds
    s_add_u32 m0, s71, 8192
    s_add_u32 s63, s64, 8192
    buffer_load_dwordx4 v20, s[52:55], s63 offen offset:0 lds
    buffer_load_dwordx4 v21, s[52:55], s63 offen offset:1024 lds
    buffer_load_dwordx4 v22, s[52:55], s63 offen offset:2048 lds
    buffer_load_dwordx4 v23, s[52:55], s63 offen offset:3072 lds
    s_add_u32 m0, s71, 12288
    s_add_u32 s63, s64, 12288
    buffer_load_dwordx4 v24, s[52:55], s63 offen offset:0 lds
    buffer_load_dwordx4 v25, s[52:55], s63 offen offset:1024 lds
    buffer_load_dwordx4 v26, s[52:55], s63 offen offset:2048 lds
    buffer_load_dwordx4 v27, s[52:55], s63 offen offset:3072 lds
    v_mov_b64 v[36:37], 0
    v_mov_b64 v[38:39], 0
    v_mov_b64 v[40:41], 0
    v_mov_b64 v[42:43], 0
    v_mov_b64 v[44:45], 0
    v_mov_b64 v[46:47], 0
    v_mov_b64 v[48:49], 0
    v_mov_b64 v[50:51], 0
    v_mov_b32 v52, 0x3f803f80
    v_mov_b32 v53, 0x3f803f80
L_A1:
    s_waitcnt vmcnt(0)
    ds_read_b128 v[128:131], v8 offset:0
    ds_read_b128 v[132:135], v9 offset:0
    ds_read_b128 v[136:139], v10 offset:0
    ds_read_b128 v[140:143], v11 offset:0
    ds_read_b128 v[144:147], v8 offset:256
    ds_read_b128 v[148:151], v9 offset:256
    ds_read_b128 v[152:155], v10 offset:256
    ds_read_b128 v[156:159], v11 offset:256
    s_waitcnt lgkmcnt(4)
    ds_read_b128 v[160:163], v8 offset:512
    ds_read_b128 v[164:167], v9 offset:512
    ds_read_b128 v[168:171], v10 offset:512
    ds_read_b128 v[172:175], v11 offset:512
    s_waitcnt lgkmcnt(4)
    ds_read_b128 v[176:179], v8 offset:768
    ds_read_b128 v[180:183], v9 offset:768
    ds_read_b128 v[184:187], v10 offset:768
    ds_read_b128 v[188:191], v11 offset:768
    v_mov_b64 v[78:79], v[74:75]
    v_mov_b64 v[76:77], v[72:73]
    v_mov_b64 v[74:75], v[70:71]
    v_mov_b64 v[72:73], v[68:69]
    v_mov_b64 v[70:71], v[66:67]
    v_mov_b64 v[68:69], v[64:65]
    v_mov_b64 v[66:67], v[62:63]
    v_mov_b64 v[64:65], v[60:61]
    v_mov_b64 v[62:63], v[58:59]
    v_mov_b64 v[60:61], v[56:57]
    s_add_u32 s76, s76, 24
    s_waitcnt lgkmcnt(0)
    s_cmp_ge_u32 s76, 128
    s_cbranch_scc1 L_A1_NOX
    s_lshl_b32 s64, s76, 14
    s_add_u32 m0, s71, 0
    s_add_u32 s63, s64, 0
    buffer_load_dwordx4 v12, s[52:55], s63 offen offset:0 lds
    buffer_load_dwordx4 v13, s[52:55], s63 offen offset:1024 lds
    buffer_load_dwordx4 v14, s[52:55], s63 offen offset:2048 lds
    buffer_load_dwordx4 v15, s[52:55], s63 offen offset:3072 lds
    s_add_u32 m0, s71, 4096
    s_add_u32 s63, s64, 4096
    buffer_load_dwordx4 v16, s[52:55], s63 offen offset:0 lds
    buffer_load_dwordx4 v17, s[52:55], s63 offen offset:1024 lds
    buffer_load_dwordx4 v18, s[52:55], s63 offen offset:2048 lds
    buffer_load_dwordx4 v19, s[52:55], s63 offen offset:3072 lds
    s_add_u32 m0, s71, 8192
    s_add_u32 s63, s64, 8192
    buffer_load_dwordx4 v20, s[52:55], s63 offen offset:0 lds
    buffer_load_dwordx4 v21, s[52:55], s63 offen offset:1024 lds
    buffer_load_dwordx4 v22, s[52:55], s63 offen offset:2048 lds
    buffer_load_dwordx4 v23, s[52:55], s63 offen offset:3072 lds
    s_add_u32 m0, s71, 12288
    s_add_u32 s63, s64, 12288
    buffer_load_dwordx4 v24, s[52:55], s63 offen offset:0 lds
    buffer_load_dwordx4 v25, s[52:55], s63 offen offset:1024 lds
    buffer_load_dwordx4 v26, s[52:55], s63 offen offset:2048 lds
    buffer_load_dwordx4 v27, s[52:55], s63 offen offset:3072 lds
L_A1_NOX:
    v_mfma_f32_16x16x32_bf16 v[80:83], a[0:3], v[128:131], 0
    v_mfma_f32_16x16x32_bf16 v[84:87], a[64:67], v[128:131], 0
    v_mfma_f32_16x16x32_bf16 v[80:83], a[4:7], v[132:135], v[80:83]
    v_mfma_f32_16x16x32_bf16 v[84:87], a[68:71], v[132:135], v[84:87]
    v_mfma_f32_16x16x32_bf16 v[80:83], a[8:11], v[136:139], v[80:83]
    v_mfma_f32_16x16x32_bf16 v[84:87], a[72:75], v[136:139], v[84:87]
    v_mfma_f32_16x16x32_bf16 v[80:83], a[12:15], v[140:143], v[80:83]
    v_mfma_f32_16x16x32_bf16 v[84:87], a[76:79], v[140:143], v[84:87]
    v_mfma_f32_16x16x32_bf16 v[80:83], a[16:19], v[144:147], v[80:83]
    v_mfma_f32_16x16x32_bf16 v[84:87], a[80:83], v[144:147], v[84:87]
    v_mfma_f32_16x16x32_bf16 v[80:83], a[20:23], v[148:151], v[80:83]
    v_mfma_f32_16x16x32_bf16 v[84:87], a[84:87], v[148:151], v[84:87]
    v_mfma_f32_16x16x32_bf16 v[80:83], a[24:27], v[152:155], v[80:83]
    v_mfma_f32_16x16x32_bf16 v[84:87], a[88:91], v[152:155], v[84:87]
    v_mfma_f32_16x16x32_bf16 v[80:83], a[28:31], v[156:159], v[80:83]
    v_mfma_f32_16x16x32_bf16 v[84:87], a[92:95], v[156:159], v[84:87]
    v_mfma_f32_16x16x32_bf16 v[80:83], a[32:35], v[160:163], v[80:83]
    v_mfma_f32_16x16x32_bf16 v[84:87], a[96:99], v[160:163], v[84:87]
    v_mfma_f32_16x16x32_bf16 v[80:83], a[36:39], v[164:167], v[80:83]
    v_mfma_f32_16x16x32_bf16 v[84:87], a[100:103], v[164:167], v[84:87]
    v_mfma_f32_16x16x32_bf16 v[80:83], a[40:43], v[168:171], v[80:83]
    v_mfma_f32_16x16x32_bf16 v[84:87], a[104:107], v[168:171], v[84:87]
    v_mfma_f32_16x16x32_bf16 v[80:83], a[44:47], v[172:175], v[80:83]
    v_mfma_f32_16x16x32_bf16 v[84:87], a[108:111], v[172:175], v[84:87]
    v_mfma_f32_16x16x32_bf16 v[80:83], a[48:51], v[176:179], v[80:83]
    v_mfma_f32_16x16x32_bf16 v[84:87], a[112:115], v[176:179], v[84:87]
    v_mfma_f32_16x16x32_bf16 v[80:83], a[52:55], v[180:183], v[80:83]
    v_mfma_f32_16x16x32_bf16 v[84:87], a[116:119], v[180:183], v[84:87]
    v_mfma_f32_16x16x32_bf16 v[80:83], a[56:59], v[184:187], v[80:83]
    v_mfma_f32_16x16x32_bf16 v[84:87], a[120:123], v[184:187], v[84:87]
    v_mfma_f32_16x16x32_bf16 v[80:83], a[60:63], v[188:191], v[80:83]
    v_mfma_f32_16x16x32_bf16 v[84:87], a[124:127], v[188:191], v[84:87]
    v_mfma_f32_16x16x32_bf16 v[88:91], v[128:131], a[128:131], 0
    v_mfma_f32_16x16x32_bf16 v[88:91], v[132:135], a[132:135], v[88:91]
    v_mfma_f32_16x16x32_bf16 v[88:91], v[136:139], a[136:139], v[88:91]
    v_mfma_f32_16x16x32_bf16 v[88:91], v[140:143], a[140:143], v[88:91]
    v_mfma_f32_16x16x32_bf16 v[88:91], v[144:147], a[144:147], v[88:91]
    v_mfma_f32_16x16x32_bf16 v[88:91], v[148:151], a[148:151], v[88:91]
    v_mfma_f32_16x16x32_bf16 v[88:91], v[152:155], a[152:155], v[88:91]
    v_mfma_f32_16x16x32_bf16 v[88:91], v[156:159], a[156:159], v[88:91]
    v_mfma_f32_16x16x32_bf16 v[88:91], v[160:163], a[160:163], v[88:91]
    v_mfma_f32_16x16x32_bf16 v[88:91], v[164:167], a[164:167], v[88:91]
    v_mfma_f32_16x16x32_bf16 v[88:91], v[168:171], a[168:171], v[88:91]
    v_mfma_f32_16x16x32_bf16 v[88:91], v[172:175], a[172:175], v[88:91]
    v_mfma_f32_16x16x32_bf16 v[88:91], v[176:179], a[176:179], v[88:91]
    v_mfma_f32_16x16x32_bf16 v[88:91], v[180:183], a[180:183], v[88:91]
    v_mfma_f32_16x16x32_bf16 v[88:91], v[184:187], a[184:187], v[88:91]
    v_mfma_f32_16x16x32_bf16 v[88:91], v[188:191], a[188:191], v[88:91]
    v_cvt_pk_bf16_f32 v212, v80, v81
    v_cvt_pk_bf16_f32 v213, v82, v83
    v_cvt_pk_bf16_f32 v236, v84, v85
    v_cvt_pk_bf16_f32 v237, v86, v87
    v_mfma_f32_16x16x16_bf16 v[192:195], v[32:33], v[212:213], 0
    s_nop 0
    v_mfma_f32_16x16x16_bf16 v[216:219], v[32:33], v[236:237], 0
    v_cvt_pk_bf16_f32 v88, v88, v89
    v_cvt_pk_bf16_f32 v89, v90, v91
    s_nop 0
    v_cvt_pk_bf16_f32 v212, v192, v193
    v_cvt_pk_bf16_f32 v213, v194, v195
    v_lshlrev_b32 v192, 16, v212
    v_and_b32 v193, 0xffff0000, v212
    v_lshlrev_b32 v194, 16, v213
    v_and_b32 v195, 0xffff0000, v213
    v_max3_f32 v204, v192, v193, v194
    v_min3_f32 v205, v192, v193, v194
    v_max_f32 v204, v204, v195
    v_min_f32 v205, v205, v195
    v_cvt_pk_bf16_f32 v236, v216, v217
    v_cvt_pk_bf16_f32 v237, v218, v219
    v_lshlrev_b32 v216, 16, v236
    v_and_b32 v217, 0xffff0000, v236
    v_lshlrev_b32 v218, 16, v237
    v_and_b32 v219, 0xffff0000, v237
    v_max3_f32 v228, v216, v217, v218
    v_min3_f32 v229, v216, v217, v218
    v_max_f32 v228, v228, v219
    v_min_f32 v229, v229, v219
    v_mov_b32 v208, v204
    v_mov_b32 v209, v205
    v_mov_b32 v232, v228
    v_mov_b32 v233, v229
    v_permlane16_swap_b32 v204, v208
    v_permlane16_swap_b32 v205, v209
    v_permlane16_swap_b32 v228, v232
    v_permlane16_swap_b32 v229, v233
    v_max_f32 v204, v204, v208
    v_min_f32 v205, v205, v209
    v_max_f32 v228, v228, v232
    v_min_f32 v229, v229, v233
    v_mov_b32 v208, v204
    v_mov_b32 v209, v205
    v_mov_b32 v232, v228
    v_mov_b32 v233, v229
    v_permlane32_swap_b32 v204, v208
    v_permlane32_swap_b32 v205, v209
    v_permlane32_swap_b32 v228, v232
    v_permlane32_swap_b32 v229, v233
    v_max_f32 v204, v204, v208
    v_min_f32 v205, v205, v209
    v_max_f32 v228, v228, v232
    v_min_f32 v229, v229, v233
    v_sub_f32 v196, v192, v204
    v_sub_f32 v200, v205, v192
    v_sub_f32 v197, v193, v204
    v_sub_f32 v201, v205, v193
    v_sub_f32 v198, v194, v204
    v_sub_f32 v202, v205, v194
    v_sub_f32 v199, v195, v204
    v_sub_f32 v203, v205, v195
    v_mul_f32 v196, s77, v196
    v_mul_f32 v197, s77, v197
    v_mul_f32 v198, s77, v198
    v_mul_f32 v199, s77, v199
    v_mul_f32 v200, s77, v200
    v_mul_f32 v201, s77, v201
    v_mul_f32 v202, s77, v202
    v_mul_f32 v203, s77, v203
    v_exp_f32 v196, v196
    v_exp_f32 v197, v197
    v_exp_f32 v198, v198
    v_exp_f32 v199, v199
    v_exp_f32 v200, v200
    v_exp_f32 v201, v201
    v_exp_f32 v202, v202
    v_exp_f32 v203, v203
    v_sub_f32 v220, v216, v228
    v_sub_f32 v224, v229, v216
    v_sub_f32 v221, v217, v228
    v_sub_f32 v225, v229, v217
    v_sub_f32 v222, v218, v228
    v_sub_f32 v226, v229, v218
    v_sub_f32 v223, v219, v228
    v_sub_f32 v227, v229, v219
    v_mul_f32 v220, s77, v220
    v_mul_f32 v221, s77, v221
    v_mul_f32 v222, s77, v222
    v_mul_f32 v223, s77, v223
    v_mul_f32 v224, s77, v224
    v_mul_f32 v225, s77, v225
    v_mul_f32 v226, s77, v226
    v_mul_f32 v227, s77, v227
    v_exp_f32 v220, v220
    v_exp_f32 v221, v221
    v_exp_f32 v222, v222
    v_exp_f32 v223, v223
    v_exp_f32 v224, v224
    v_exp_f32 v225, v225
    v_exp_f32 v226, v226
    v_exp_f32 v227, v227
    v_add_f32 v206, v196, v197
    v_add_f32 v208, v198, v199
    v_add_f32 v206, v206, v208
    v_add_f32 v207, v200, v201
    v_add_f32 v208, v202, v203
    v_add_f32 v207, v207, v208
    v_add_f32 v230, v220, v221
    v_add_f32 v232, v222, v223
    v_add_f32 v230, v230, v232
    v_add_f32 v231, v224, v225
    v_add_f32 v232, v226, v227
    v_add_f32 v231, v231, v232
    v_mov_b32 v208, v206
    v_mov_b32 v209, v207
    v_mov_b32 v232, v230
    v_mov_b32 v233, v231
    v_permlane16_swap_b32 v206, v208
    v_permlane16_swap_b32 v207, v209
    v_permlane16_swap_b32 v230, v232
    v_permlane16_swap_b32 v231, v233
    v_add_f32 v206, v206, v208
    v_add_f32 v207, v207, v209
    v_add_f32 v230, v230, v232
    v_add_f32 v231, v231, v233
    v_mov_b32 v208, v206
    v_mov_b32 v209, v207
    v_mov_b32 v232, v230
    v_mov_b32 v233, v231
    v_permlane32_swap_b32 v206, v208
    v_permlane32_swap_b32 v207, v209
    v_permlane32_swap_b32 v230, v232
    v_permlane32_swap_b32 v231, v233
    v_add_f32 v206, v206, v208
    v_add_f32 v207, v207, v209
    v_add_f32 v230, v230, v232
    v_add_f32 v231, v231, v233
    v_rcp_f32 v230, v230
    v_rcp_f32 v231, v231
    v_rcp_f32 v206, v206
    v_rcp_f32 v207, v207
    v_mul_f32 v220, v230, v220
    v_mul_f32 v224, v231, v224
    v_mul_f32 v221, v230, v221
    v_mul_f32 v225, v231, v225
    v_mul_f32 v222, v230, v222
    v_mul_f32 v226, v231, v226
    v_mul_f32 v223, v230, v223
    v_mul_f32 v227, v231, v227
    v_cvt_pk_bf16_f32 v216, v220, v221
    v_cvt_pk_bf16_f32 v217, v222, v223
    v_cvt_pk_bf16_f32 v218, v224, v225
    v_cvt_pk_bf16_f32 v219, v226, v227
    v_mfma_f32_16x16x16_bf16 v[220:223], v[216:217], v[28:29], 0
    s_nop 0
    v_mfma_f32_16x16x16_bf16 v[224:227], v[218:219], v[28:29], 0
    v_mul_f32 v196, v206, v196
    v_mul_f32 v200, v207, v200
    v_mul_f32 v197, v206, v197
    v_mul_f32 v201, v207, v201
    v_mul_f32 v198, v206, v198
    v_mul_f32 v202, v207, v202
    v_mul_f32 v199, v206, v199
    v_mul_f32 v203, v207, v203
    v_cvt_pk_bf16_f32 v56, v196, v197
    v_cvt_pk_bf16_f32 v57, v198, v199
    v_cvt_pk_bf16_f32 v58, v200, v201
    v_cvt_pk_bf16_f32 v59, v202, v203
    v_cvt_pk_bf16_f32 v216, v220, v221
    v_cvt_pk_bf16_f32 v217, v222, v223
    v_cvt_pk_bf16_f32 v218, v224, v225
    v_cvt_pk_bf16_f32 v219, v226, v227
    v_mfma_f32_16x16x16_bf16 v[36:39], v[216:217], v[88:89], v[36:39]
    s_nop 0
    v_mfma_f32_16x16x16_bf16 v[40:43], v[218:219], v[88:89], v[40:43]
    v_mfma_f32_16x16x16_bf16 v[44:47], v[216:217], v[52:53], v[44:47]
    v_mfma_f32_16x16x16_bf16 v[48:51], v[218:219], v[52:53], v[48:51]
    s_cmp_lt_u32 s76, 128
    s_cbranch_scc1 L_A1
    v_add_u32 v30, s71, v1
    s_lshl_b32 s63, s56, 10
    s_add_u32 s63, s63, 0
    v_add_u32 v31, s63, v1
    ds_write_b128 v30, v[36:39] offset:0
    ds_write_b128 v30, v[40:43] offset:1024
    ds_write_b128 v30, v[44:47] offset:2048
    ds_write_b128 v30, v[48:51] offset:3072
    s_waitcnt lgkmcnt(0)
    s_barrier
    ds_read_b128 v[36:39], v31 offset:0
    ds_read_b128 v[40:43], v31 offset:16384
    ds_read_b128 v[44:47], v31 offset:32768
    ds_read_b128 v[48:51], v31 offset:49152
    s_lshl_b32 s72, s57, 15
    s_lshl_b32 s63, s56, 10
    s_add_u32 s72, s72, s63
    s_add_u32 s72, s72, 61865984
    s_lshl_b32 s63, s58, 12
    s_add_u32 s63, s63, s72
    s_waitcnt lgkmcnt(0)
    v_add_f32 v36, v36, v40
    v_add_f32 v44, v44, v48
    v_add_f32 v36, v36, v44
    v_add_f32 v37, v37, v41
    v_add_f32 v45, v45, v49
    v_add_f32 v37, v37, v45
    v_add_f32 v38, v38, v42
    v_add_f32 v46, v46, v50
    v_add_f32 v38, v38, v46
    v_add_f32 v39, v39, v43
    v_add_f32 v47, v47, v51
    v_add_f32 v39, v39, v47
    buffer_store_dwordx4 v[36:39], v1, s[36:39], s63 offen sc1
    s_waitcnt vmcnt(0)
    s_barrier
    s_cmp_lg_u32 s56, 0
    s_cbranch_scc1 L_fs_16
    s_lshl_b32 s63, s57, 7
    s_lshl_b32 s64, s58, 2
    s_add_u32 s63, s63, s64
    s_add_u32 s63, s63, 64040960
    v_mov_b32 v30, 1
    buffer_store_dword v30, off, s[36:39], s63 sc1
L_fs_16:
    s_mov_b32 s44, s14
    s_and_b32 s45, s15, 0xffff
    s_mov_b32 s46, 524288
    s_mov_b32 s47, 0x20000
    s_lshl_b32 s67, s56, 14
    s_add_u32 s67, s67, 0
    v_add_u32 v6, s67, v6
    v_lshrrev_b32 v4, 2, v0
    v_lshlrev_b32 v4, 10, v4
    v_lshl_add_u32 v4, v7, 4, v4
    s_lshl_b32 s73, s60, 6
    s_add_u32 m0, s67, 0
    s_add_u32 s63, s73, 0
    buffer_load_dwordx4 v4, s[44:47], s63 offen  lds
    s_add_u32 m0, s67, 1024
    s_add_u32 s63, s73, 16384
    buffer_load_dwordx4 v4, s[44:47], s63 offen  lds
    s_add_u32 m0, s67, 2048
    s_add_u32 s63, s73, 32768
    buffer_load_dwordx4 v4, s[44:47], s63 offen  lds
    s_add_u32 m0, s67, 3072
    s_add_u32 s63, s73, 49152
    buffer_load_dwordx4 v4, s[44:47], s63 offen  lds
    s_add_u32 m0, s67, 4096
    s_add_u32 s63, s73, 65536
    buffer_load_dwordx4 v4, s[44:47], s63 offen  lds
    s_add_u32 m0, s67, 5120
    s_add_u32 s63, s73, 81920
    buffer_load_dwordx4 v4, s[44:47], s63 offen  lds
    s_add_u32 m0, s67, 6144
    s_add_u32 s63, s73, 98304
    buffer_load_dwordx4 v4, s[44:47], s63 offen  lds
    s_add_u32 m0, s67, 7168
    s_add_u32 s63, s73, 114688
    buffer_load_dwordx4 v4, s[44:47], s63 offen  lds
    s_add_u32 m0, s67, 8192
    s_add_u32 s63, s73, 131072
    buffer_load_dwordx4 v4, s[44:47], s63 offen  lds
    s_add_u32 m0, s67, 9216
    s_add_u32 s63, s73, 147456
    buffer_load_dwordx4 v4, s[44:47], s63 offen  lds
    s_add_u32 m0, s67, 10240
    s_add_u32 s63, s73, 163840
    buffer_load_dwordx4 v4, s[44:47], s63 offen  lds
    s_add_u32 m0, s67, 11264
    s_add_u32 s63, s73, 180224
    buffer_load_dwordx4 v4, s[44:47], s63 offen  lds
    s_waitcnt vmcnt(8)
    ds_read_b64_tr_b16 a[0:1], v6 offset:0
    ds_read_b64_tr_b16 a[2:3], v6 offset:1024
    ds_read_b64_tr_b16 a[4:5], v6 offset:2048
    ds_read_b64_tr_b16 a[6:7], v6 offset:3072
    ds_read_b64_tr_b16 a[8:9], v6 offset:8
    ds_read_b64_tr_b16 a[10:11], v6 offset:1032
    ds_read_b64_tr_b16 a[12:13], v6 offset:2056
    ds_read_b64_tr_b16 a[14:15], v6 offset:3080
    s_waitcnt lgkmcnt(8)
    s_add_u32 m0, s67, 12288
    s_add_u32 s63, s73, 196608
    buffer_load_dwordx4 v4, s[44:47], s63 offen  lds
    s_add_u32 m0, s67, 13312
    s_add_u32 s63, s73, 212992
    buffer_load_dwordx4 v4, s[44:47], s63 offen  lds
    s_add_u32 m0, s67, 14336
    s_add_u32 s63, s73, 229376
    buffer_load_dwordx4 v4, s[44:47], s63 offen  lds
    s_add_u32 m0, s67, 15360
    s_add_u32 s63, s73, 245760
    buffer_load_dwordx4 v4, s[44:47], s63 offen  lds
    s_waitcnt vmcnt(8)
    ds_read_b64_tr_b16 a[16:17], v6 offset:4096
    ds_read_b64_tr_b16 a[18:19], v6 offset:5120
    ds_read_b64_tr_b16 a[20:21], v6 offset:6144
    ds_read_b64_tr_b16 a[22:23], v6 offset:7168
    ds_read_b64_tr_b16 a[24:25], v6 offset:4104
    ds_read_b64_tr_b16 a[26:27], v6 offset:5128
    ds_read_b64_tr_b16 a[28:29], v6 offset:6152
    ds_read_b64_tr_b16 a[30:31], v6 offset:7176
    s_waitcnt lgkmcnt(8)
    s_add_u32 m0, s67, 0
    s_add_u32 s63, s73, 262144
    buffer_load_dwordx4 v4, s[44:47], s63 offen  lds
    s_add_u32 m0, s67, 1024
    s_add_u32 s63, s73, 278528
    buffer_load_dwordx4 v4, s[44:47], s63 offen  lds
    s_add_u32 m0, s67, 2048
    s_add_u32 s63, s73, 294912
    buffer_load_dwordx4 v4, s[44:47], s63 offen  lds
    s_add_u32 m0, s67, 3072
    s_add_u32 s63, s73, 311296
    buffer_load_dwordx4 v4, s[44:47], s63 offen  lds
    s_waitcnt vmcnt(8)
    ds_read_b64_tr_b16 a[32:33], v6 offset:8192
    ds_read_b64_tr_b16 a[34:35], v6 offset:9216
    ds_read_b64_tr_b16 a[36:37], v6 offset:10240
    ds_read_b64_tr_b16 a[38:39], v6 offset:11264
    ds_read_b64_tr_b16 a[40:41], v6 offset:8200
    ds_read_b64_tr_b16 a[42:43], v6 offset:9224
    ds_read_b64_tr_b16 a[44:45], v6 offset:10248
    ds_read_b64_tr_b16 a[46:47], v6 offset:11272
    s_waitcnt lgkmcnt(8)
    s_add_u32 m0, s67, 4096
    s_add_u32 s63, s73, 327680
    buffer_load_dwordx4 v4, s[44:47], s63 offen  lds
    s_add_u32 m0, s67, 5120
    s_add_u32 s63, s73, 344064
    buffer_load_dwordx4 v4, s[44:47], s63 offen  lds
    s_add_u32 m0, s67, 6144
    s_add_u32 s63, s73, 360448
    buffer_load_dwordx4 v4, s[44:47], s63 offen  lds
    s_add_u32 m0, s67, 7168
    s_add_u32 s63, s73, 376832
    buffer_load_dwordx4 v4, s[44:47], s63 offen  lds
    s_waitcnt vmcnt(8)
    ds_read_b64_tr_b16 a[48:49], v6 offset:12288
    ds_read_b64_tr_b16 a[50:51], v6 offset:13312
    ds_read_b64_tr_b16 a[52:53], v6 offset:14336
    ds_read_b64_tr_b16 a[54:55], v6 offset:15360
    ds_read_b64_tr_b16 a[56:57], v6 offset:12296
    ds_read_b64_tr_b16 a[58:59], v6 offset:13320
    ds_read_b64_tr_b16 a[60:61], v6 offset:14344
    ds_read_b64_tr_b16 a[62:63], v6 offset:15368
    s_waitcnt lgkmcnt(8)
    s_add_u32 m0, s67, 8192
    s_add_u32 s63, s73, 393216
    buffer_load_dwordx4 v4, s[44:47], s63 offen  lds
    s_add_u32 m0, s67, 9216
    s_add_u32 s63, s73, 409600
    buffer_load_dwordx4 v4, s[44:47], s63 offen  lds
    s_add_u32 m0, s67, 10240
    s_add_u32 s63, s73, 425984
    buffer_load_dwordx4 v4, s[44:47], s63 offen  lds
    s_add_u32 m0, s67, 11264
    s_add_u32 s63, s73, 442368
    buffer_load_dwordx4 v4, s[44:47], s63 offen  lds
    s_waitcnt vmcnt(8)
    ds_read_b64_tr_b16 a[64:65], v6 offset:0
    ds_read_b64_tr_b16 a[66:67], v6 offset:1024
    ds_read_b64_tr_b16 a[68:69], v6 offset:2048
    ds_read_b64_tr_b16 a[70:71], v6 offset:3072
    ds_read_b64_tr_b16 a[72:73], v6 offset:8
    ds_read_b64_tr_b16 a[74:75], v6 offset:1032
    ds_read_b64_tr_b16 a[76:77], v6 offset:2056
    ds_read_b64_tr_b16 a[78:79], v6 offset:3080
    s_waitcnt lgkmcnt(8)
    s_add_u32 m0, s67, 12288
    s_add_u32 s63, s73, 458752
    buffer_load_dwordx4 v4, s[44:47], s63 offen  lds
    s_add_u32 m0, s67, 13312
    s_add_u32 s63, s73, 475136
    buffer_load_dwordx4 v4, s[44:47], s63 offen  lds
    s_add_u32 m0, s67, 14336
    s_add_u32 s63, s73, 491520
    buffer_load_dwordx4 v4, s[44:47], s63 offen  lds
    s_add_u32 m0, s67, 15360
    s_add_u32 s63, s73, 507904
    buffer_load_dwordx4 v4, s[44:47], s63 offen  lds
    s_waitcnt vmcnt(8)
    ds_read_b64_tr_b16 a[80:81], v6 offset:4096
    ds_read_b64_tr_b16 a[82:83], v6 offset:5120
    ds_read_b64_tr_b16 a[84:85], v6 offset:6144
    ds_read_b64_tr_b16 a[86:87], v6 offset:7168
    ds_read_b64_tr_b16 a[88:89], v6 offset:4104
    ds_read_b64_tr_b16 a[90:91], v6 offset:5128
    ds_read_b64_tr_b16 a[92:93], v6 offset:6152
    ds_read_b64_tr_b16 a[94:95], v6 offset:7176
    s_waitcnt vmcnt(4)
    ds_read_b64_tr_b16 a[96:97], v6 offset:8192
    ds_read_b64_tr_b16 a[98:99], v6 offset:9216
    ds_read_b64_tr_b16 a[100:101], v6 offset:10240
    ds_read_b64_tr_b16 a[102:103], v6 offset:11264
    ds_read_b64_tr_b16 a[104:105], v6 offset:8200
    ds_read_b64_tr_b16 a[106:107], v6 offset:9224
    ds_read_b64_tr_b16 a[108:109], v6 offset:10248
    ds_read_b64_tr_b16 a[110:111], v6 offset:11272
    s_waitcnt vmcnt(0)
    ds_read_b64_tr_b16 a[112:113], v6 offset:12288
    ds_read_b64_tr_b16 a[114:115], v6 offset:13312
    ds_read_b64_tr_b16 a[116:117], v6 offset:14336
    ds_read_b64_tr_b16 a[118:119], v6 offset:15360
    ds_read_b64_tr_b16 a[120:121], v6 offset:12296
    ds_read_b64_tr_b16 a[122:123], v6 offset:13320
    ds_read_b64_tr_b16 a[124:125], v6 offset:14344
    ds_read_b64_tr_b16 a[126:127], v6 offset:15368
    s_waitcnt lgkmcnt(0)
    v_and_b32 v82, 7, v0
    v_lshlrev_b32 v82, 5, v82
    s_cmp_eq_u32 s96, 0
    s_cselect_b32 s63, 0, 8
    v_add_u32 v82, s63, v82
    buffer_load_dwordx2 v[80:81], v82, s[40:43], 0 offen sc1
    s_waitcnt vmcnt(0)
L_arr_17:
    s_mov_b32 s64, 0
    v_readlane_b32 s63, v81, 0
    s_nop 0
    s_lshr_b32 s63, s63, 8
    s_add_u32 s64, s64, s63
    v_readlane_b32 s63, v81, 1
    s_nop 0
    s_lshr_b32 s63, s63, 8
    s_add_u32 s64, s64, s63
    v_readlane_b32 s63, v81, 2
    s_nop 0
    s_lshr_b32 s63, s63, 8
    s_add_u32 s64, s64, s63
    v_readlane_b32 s63, v81, 3
    s_nop 0
    s_lshr_b32 s63, s63, 8
    s_add_u32 s64, s64, s63
    v_readlane_b32 s63, v81, 4
    s_nop 0
    s_lshr_b32 s63, s63, 8
    s_add_u32 s64, s64, s63
    v_readlane_b32 s63, v81, 5
    s_nop 0
    s_lshr_b32 s63, s63, 8
    s_add_u32 s64, s64, s63
    v_readlane_b32 s63, v81, 6
    s_nop 0
    s_lshr_b32 s63, s63, 8
    s_add_u32 s64, s64, s63
    v_readlane_b32 s63, v81, 7
    s_nop 0
    s_lshr_b32 s63, s63, 8
    s_add_u32 s64, s64, s63
    s_cmp_ge_u32 s64, 256
    s_cbranch_scc1 L_arrd_18
    buffer_load_dwordx2 v[80:81], v82, s[40:43], 0 offen sc1
    s_sub_u32 s61, s61, 1
    s_cbranch_scc1 L_END
    s_waitcnt vmcnt(0)
    s_branch L_arr_17
L_arrd_18:
    s_cmp_lg_u32 s96, 0
    s_cbranch_scc1 L_arrk_19
    v_cmp_ne_u32 vcc, -1, v80
    s_cbranch_vccnz L_RESTART
    v_cmp_ne_u32 vcc, 8192, v81
    s_cbranch_vccnz L_RESTART
L_arrk_19:
    v_min_u32 v30, 5, v0
    v_lshlrev_b32 v30, 2, v30
    s_lshl_b32 s64, s57, 7
    s_add_u32 s64, s64, 64040960
    s_cmp_lg_u32 s56, 0
    s_cbranch_scc1 L_polld_21
L_poll_20:
    buffer_load_dword v31, v30, s[36:39], s64 offen sc1
    s_sub_u32 s61, s61, 1
    s_cbranch_scc1 L_END
    s_waitcnt vmcnt(0)
    v_cmp_gt_u32 vcc, 1, v31
    s_cbranch_vccz L_polld_21
    s_sleep 2
    s_branch L_poll_20
L_polld_21:
    s_barrier
    s_add_u32 s63, s72, 0
    buffer_load_dwordx4 v[80:83], v1, s[36:39], s63 offen sc1
    s_add_u32 s63, s72, 4096
    buffer_load_dwordx4 v[84:87], v1, s[36:39], s63 offen sc1
    s_add_u32 s63, s72, 8192
    buffer_load_dwordx4 v[88:91], v1, s[36:39], s63 offen sc1
    s_add_u32 s63, s72, 12288
    buffer_load_dwordx4 v[92:95], v1, s[36:39], s63 offen sc1
    s_add_u32 s63, s72, 16384
    buffer_load_dwordx4 v[96:99], v1, s[36:39], s63 offen sc1
    s_add_u32 s63, s72, 20480
    buffer_load_dwordx4 v[100:103], v1, s[36:39], s63 offen sc1
    v_lshrrev_b32 v30, 1, v1
    v_add_u32 v31, 155648, v30
    s_lshl_b32 s63, s56, 9
    v_add_u32 v108, s63, v31
    s_waitcnt vmcnt(4)
    v_add_f32 v80, v80, v84
    v_add_f32 v81, v81, v85
    v_add_f32 v82, v82, v86
    v_add_f32 v83, v83, v87
    s_waitcnt vmcnt(3)
    v_add_f32 v80, v80, v88
    v_add_f32 v81, v81, v89
    v_add_f32 v82, v82, v90
    v_add_f32 v83, v83, v91
    s_waitcnt vmcnt(2)
    v_add_f32 v80, v80, v92
    v_add_f32 v81, v81, v93
    v_add_f32 v82, v82, v94
    v_add_f32 v83, v83, v95
    s_waitcnt vmcnt(1)
    v_add_f32 v80, v80, v96
    v_add_f32 v81, v81, v97
    v_add_f32 v82, v82, v98
    v_add_f32 v83, v83, v99
    s_waitcnt vmcnt(0)
    v_add_f32 v80, v80, v100
    v_add_f32 v81, v81, v101
    v_add_f32 v82, v82, v102
    v_add_f32 v83, v83, v103
    v_cvt_pk_bf16_f32 v80, v80, v81
    v_cvt_pk_bf16_f32 v81, v82, v83
    ds_write_b64 v108, v[80:81]
    s_waitcnt lgkmcnt(0)
    s_barrier
    ds_read_b64 v[36:37], v31
    ds_read_b64 v[38:39], v31 offset:512
    ds_read_b64 v[40:41], v31 offset:1024
    ds_read_b64 v[42:43], v31 offset:1536
    s_lshl_b32 s72, s57, 9
    s_add_u32 s72, s72, 59768832
    s_mov_b32 s77, 0x358637bd
    s_waitcnt lgkmcnt(0)
L_A2:
    s_sub_u32 s76, s76, 24
    v_mfma_f32_16x16x32_bf16 v[80:83], v[36:39], v[56:59], 0
    v_mfma_f32_16x16x32_bf16 v[84:87], v[40:43], v[56:59], 0
    v_mov_b64 v[56:57], v[60:61]
    v_mov_b64 v[58:59], v[62:63]
    v_mov_b64 v[60:61], v[64:65]
    v_mov_b64 v[62:63], v[66:67]
    v_mov_b64 v[64:65], v[68:69]
    v_mov_b64 v[66:67], v[70:71]
    v_mov_b64 v[68:69], v[72:73]
    v_mov_b64 v[70:71], v[74:75]
    v_mov_b64 v[72:73], v[76:77]
    v_mov_b64 v[74:75], v[78:79]
    s_lshl_b32 s63, s76, 14
    s_add_u32 s63, s63, s72
    v_cvt_pk_bf16_f32 v88, v84, v84
    v_cvt_pk_bf16_f32 v89, v80, v81
    v_cvt_pk_bf16_f32 v90, v82, v83
    v_lshlrev_b32 v88, 16, v88
    v_add_f32 v88, s77, v88
    v_cvt_pk_bf16_f32 v88, v88, v88
    v_lshlrev_b32 v88, 16, v88
    v_rcp_f32 v88, v88
    v_lshlrev_b32 v80, 16, v89
    v_and_b32 v81, 0xffff0000, v89
    v_lshlrev_b32 v82, 16, v90
    v_and_b32 v83, 0xffff0000, v90
    v_mul_f32 v80, v88, v80
    v_mul_f32 v81, v88, v81
    v_mul_f32 v82, v88, v82
    v_mul_f32 v83, v88, v83
    v_cvt_pk_bf16_f32 v92, v80, v81
    v_cvt_pk_bf16_f32 v93, v82, v83
    buffer_store_dwordx2 v[92:93], v30, s[36:39], s63 offen sc1
    s_cmp_ge_u32 s76, 24
    s_cbranch_scc1 L_A2
    s_waitcnt vmcnt(0)
    s_barrier
    s_cmp_lg_u32 s56, 0
    s_cbranch_scc1 L_fs_22
    s_lshl_b32 s63, s58, 12
    s_lshl_b32 s64, s57, 7
    s_add_u32 s63, s63, s64
    s_add_u32 s63, s63, 62947328
    v_mov_b32 v30, 1
    buffer_store_dword v30, off, s[36:39], s63 sc1
L_fs_22:
    s_mov_b32 s52, s30
    s_and_b32 s53, s31, 0xffff
    s_mov_b32 s54, 4194304
    s_mov_b32 s55, 0x20000
    v_lshlrev_b32 v34, 11, v3
    v_lshl_add_u32 v34, v2, 4, v34
    v_and_b32 v35, 31, v0
    v_lshlrev_b32 v35, 7, v35
    s_cmp_ge_u32 s59, 6
    s_cselect_b32 s64, 6, 0
    s_sub_u32 s64, s59, s64
    s_lshl_b32 s64, s64, 12
    s_add_u32 s64, s64, 62947328
    s_cmp_lg_u32 s56, 0
    s_cbranch_scc1 L_polld_24
L_poll_23:
    buffer_load_dword v31, v35, s[36:39], s64 offen sc1
    s_sub_u32 s61, s61, 1
    s_cbranch_scc1 L_END
    s_waitcnt vmcnt(0)
    v_cmp_gt_u32 vcc, 1, v31
    s_cbranch_vccz L_polld_24
    s_sleep 2
    s_branch L_poll_23
L_polld_24:
    s_barrier
    v_lshrrev_b32 v30, 1, v1
    s_mul_i32 s76, s56, 12
    s_add_u32 s76, s76, s59
L_A3:
    s_lshl_b32 s64, s76, 14
    s_add_u32 s64, s64, 59768832
    s_add_u32 s63, s64, 0
    buffer_load_dwordx2 v[128:129], v30, s[36:39], s63 offen offset:0 sc1
    buffer_load_dwordx2 v[130:131], v30, s[36:39], s63 offen offset:512 sc1
    buffer_load_dwordx2 v[132:133], v30, s[36:39], s63 offen offset:1024 sc1
    buffer_load_dwordx2 v[134:135], v30, s[36:39], s63 offen offset:1536 sc1
    buffer_load_dwordx2 v[136:137], v30, s[36:39], s63 offen offset:2048 sc1
    buffer_load_dwordx2 v[138:139], v30, s[36:39], s63 offen offset:2560 sc1
    buffer_load_dwordx2 v[140:141], v30, s[36:39], s63 offen offset:3072 sc1
    buffer_load_dwordx2 v[142:143], v30, s[36:39], s63 offen offset:3584 sc1
    s_add_u32 s63, s64, 4096
    buffer_load_dwordx2 v[144:145], v30, s[36:39], s63 offen offset:0 sc1
    buffer_load_dwordx2 v[146:147], v30, s[36:39], s63 offen offset:512 sc1
    buffer_load_dwordx2 v[148:149], v30, s[36:39], s63 offen offset:1024 sc1
    buffer_load_dwordx2 v[150:151], v30, s[36:39], s63 offen offset:1536 sc1
    buffer_load_dwordx2 v[152:153], v30, s[36:39], s63 offen offset:2048 sc1
    buffer_load_dwordx2 v[154:155], v30, s[36:39], s63 offen offset:2560 sc1
    buffer_load_dwordx2 v[156:157], v30, s[36:39], s63 offen offset:3072 sc1
    buffer_load_dwordx2 v[158:159], v30, s[36:39], s63 offen offset:3584 sc1
    s_add_u32 s63, s64, 8192
    buffer_load_dwordx2 v[160:161], v30, s[36:39], s63 offen offset:0 sc1
    buffer_load_dwordx2 v[162:163], v30, s[36:39], s63 offen offset:512 sc1
    buffer_load_dwordx2 v[164:165], v30, s[36:39], s63 offen offset:1024 sc1
    buffer_load_dwordx2 v[166:167], v30, s[36:39], s63 offen offset:1536 sc1
    buffer_load_dwordx2 v[168:169], v30, s[36:39], s63 offen offset:2048 sc1
    buffer_load_dwordx2 v[170:171], v30, s[36:39], s63 offen offset:2560 sc1
    buffer_load_dwordx2 v[172:173], v30, s[36:39], s63 offen offset:3072 sc1
    buffer_load_dwordx2 v[174:175], v30, s[36:39], s63 offen offset:3584 sc1
    s_add_u32 s63, s64, 12288
    buffer_load_dwordx2 v[176:177], v30, s[36:39], s63 offen offset:0 sc1
    buffer_load_dwordx2 v[178:179], v30, s[36:39], s63 offen offset:512 sc1
    buffer_load_dwordx2 v[180:181], v30, s[36:39], s63 offen offset:1024 sc1
    buffer_load_dwordx2 v[182:183], v30, s[36:39], s63 offen offset:1536 sc1
    buffer_load_dwordx2 v[184:185], v30, s[36:39], s63 offen offset:2048 sc1
    buffer_load_dwordx2 v[186:187], v30, s[36:39], s63 offen offset:2560 sc1
    buffer_load_dwordx2 v[188:189], v30, s[36:39], s63 offen offset:3072 sc1
    buffer_load_dwordx2 v[190:191], v30, s[36:39], s63 offen offset:3584 sc1
    s_waitcnt vmcnt(30)
    v_mfma_f32_16x16x32_bf16 v[80:83], a[0:3], v[128:131], 0
    v_mfma_f32_16x16x32_bf16 v[84:87], a[8:11], v[128:131], 0
    s_waitcnt vmcnt(28)
    v_mfma_f32_16x16x32_bf16 v[80:83], a[4:7], v[132:135], v[80:83]
    v_mfma_f32_16x16x32_bf16 v[84:87], a[12:15], v[132:135], v[84:87]
    s_waitcnt vmcnt(26)
    v_mfma_f32_16x16x32_bf16 v[80:83], a[16:19], v[136:139], v[80:83]
    v_mfma_f32_16x16x32_bf16 v[84:87], a[24:27], v[136:139], v[84:87]
    s_waitcnt vmcnt(24)
    v_mfma_f32_16x16x32_bf16 v[80:83], a[20:23], v[140:143], v[80:83]
    v_mfma_f32_16x16x32_bf16 v[84:87], a[28:31], v[140:143], v[84:87]
    s_waitcnt vmcnt(22)
    v_mfma_f32_16x16x32_bf16 v[80:83], a[32:35], v[144:147], v[80:83]
    v_mfma_f32_16x16x32_bf16 v[84:87], a[40:43], v[144:147], v[84:87]
    s_waitcnt vmcnt(20)
    v_mfma_f32_16x16x32_bf16 v[80:83], a[36:39], v[148:151], v[80:83]
    v_mfma_f32_16x16x32_bf16 v[84:87], a[44:47], v[148:151], v[84:87]
    s_waitcnt vmcnt(18)
    v_mfma_f32_16x16x32_bf16 v[80:83], a[48:51], v[152:155], v[80:83]
    v_mfma_f32_16x16x32_bf16 v[84:87], a[56:59], v[152:155], v[84:87]
    s_waitcnt vmcnt(16)
    v_mfma_f32_16x16x32_bf16 v[80:83], a[52:55], v[156:159], v[80:83]
    v_mfma_f32_16x16x32_bf16 v[84:87], a[60:63], v[156:159], v[84:87]
    s_waitcnt vmcnt(14)
    v_mfma_f32_16x16x32_bf16 v[80:83], a[64:67], v[160:163], v[80:83]
    v_mfma_f32_16x16x32_bf16 v[84:87], a[72:75], v[160:163], v[84:87]
    s_waitcnt vmcnt(12)
    v_mfma_f32_16x16x32_bf16 v[80:83], a[68:71], v[164:167], v[80:83]
    v_mfma_f32_16x16x32_bf16 v[84:87], a[76:79], v[164:167], v[84:87]
    s_waitcnt vmcnt(10)
    v_mfma_f32_16x16x32_bf16 v[80:83], a[80:83], v[168:171], v[80:83]
    v_mfma_f32_16x16x32_bf16 v[84:87], a[88:91], v[168:171], v[84:87]
    s_waitcnt vmcnt(8)
    v_mfma_f32_16x16x32_bf16 v[80:83], a[84:87], v[172:175], v[80:83]
    v_mfma_f32_16x16x32_bf16 v[84:87], a[92:95], v[172:175], v[84:87]
    s_waitcnt vmcnt(6)
    v_mfma_f32_16x16x32_bf16 v[80:83], a[96:99], v[176:179], v[80:83]
    v_mfma_f32_16x16x32_bf16 v[84:87], a[104:107], v[176:179], v[84:87]
    s_waitcnt vmcnt(4)
    v_mfma_f32_16x16x32_bf16 v[80:83], a[100:103], v[180:183], v[80:83]
    v_mfma_f32_16x16x32_bf16 v[84:87], a[108:111], v[180:183], v[84:87]
    s_waitcnt vmcnt(2)
    v_mfma_f32_16x16x32_bf16 v[80:83], a[112:115], v[184:187], v[80:83]
    v_mfma_f32_16x16x32_bf16 v[84:87], a[120:123], v[184:187], v[84:87]
    s_waitcnt vmcnt(0)
    v_mfma_f32_16x16x32_bf16 v[80:83], a[116:119], v[188:191], v[80:83]
    v_mfma_f32_16x16x32_bf16 v[84:87], a[124:127], v[188:191], v[84:87]
    s_lshl_b32 s63, s76, 15
    s_add_u32 s63, s63, s73
    s_add_u32 s76, s76, 48
    s_nop 0
    v_cvt_pk_bf16_f32 v88, v80, v81
    v_cvt_pk_bf16_f32 v89, v82, v83
    s_nop 1
    v_cvt_pk_bf16_f32 v90, v84, v85
    v_cvt_pk_bf16_f32 v91, v86, v87
    buffer_store_dwordx4 v[88:91], v34, s[52:55], s63 offen
    s_cmp_lt_u32 s76, 128
    s_waitcnt vmcnt(0)
    s_cbranch_scc1 L_A3
    s_mov_b32 s44, s26
    s_and_b32 s45, s27, 0xffff
    s_mov_b32 s46, 4194304
    s_mov_b32 s47, 0x20000
    s_lshl_b32 s63, s56, 20
    s_add_u32 s72, s73, s63
    s_xor_b32 s74, s60, 0
    s_lshl_b32 s74, s74, 16
    s_add_u32 s74, s74, s72
    s_add_u32 m0, s67, 0
    s_add_u32 s63, s74, 0
    buffer_load_dwordx4 v4, s[44:47], s63 offen  lds
    s_add_u32 m0, s67, 1024
    s_add_u32 s63, s74, 16384
    buffer_load_dwordx4 v4, s[44:47], s63 offen  lds
    s_add_u32 m0, s67, 2048
    s_add_u32 s63, s74, 32768
    buffer_load_dwordx4 v4, s[44:47], s63 offen  lds
    s_add_u32 m0, s67, 3072
    s_add_u32 s63, s74, 49152
    buffer_load_dwordx4 v4, s[44:47], s63 offen  lds
    s_xor_b32 s74, s60, 1
    s_lshl_b32 s74, s74, 16
    s_add_u32 s74, s74, s72
    s_add_u32 m0, s67, 4096
    s_add_u32 s63, s74, 0
    buffer_load_dwordx4 v4, s[44:47], s63 offen  lds
    s_add_u32 m0, s67, 5120
    s_add_u32 s63, s74, 16384
    buffer_load_dwordx4 v4, s[44:47], s63 offen  lds
    s_add_u32 m0, s67, 6144
    s_add_u32 s63, s74, 32768
    buffer_load_dwordx4 v4, s[44:47], s63 offen  lds
    s_add_u32 m0, s67, 7168
    s_add_u32 s63, s74, 49152
    buffer_load_dwordx4 v4, s[44:47], s63 offen  lds
    s_xor_b32 s74, s60, 2
    s_lshl_b32 s74, s74, 16
    s_add_u32 s74, s74, s72
    s_add_u32 m0, s67, 8192
    s_add_u32 s63, s74, 0
    buffer_load_dwordx4 v4, s[44:47], s63 offen  lds
    s_add_u32 m0, s67, 9216
    s_add_u32 s63, s74, 16384
    buffer_load_dwordx4 v4, s[44:47], s63 offen  lds
    s_add_u32 m0, s67, 10240
    s_add_u32 s63, s74, 32768
    buffer_load_dwordx4 v4, s[44:47], s63 offen  lds
    s_add_u32 m0, s67, 11264
    s_add_u32 s63, s74, 49152
    buffer_load_dwordx4 v4, s[44:47], s63 offen  lds
    s_waitcnt vmcnt(8)
    ds_read_b64_tr_b16 a[0:1], v6 offset:0
    ds_read_b64_tr_b16 a[2:3], v6 offset:1024
    ds_read_b64_tr_b16 a[4:5], v6 offset:2048
    ds_read_b64_tr_b16 a[6:7], v6 offset:3072
    ds_read_b64_tr_b16 a[8:9], v6 offset:8
    ds_read_b64_tr_b16 a[10:11], v6 offset:1032
    ds_read_b64_tr_b16 a[12:13], v6 offset:2056
    ds_read_b64_tr_b16 a[14:15], v6 offset:3080
    s_waitcnt lgkmcnt(8)
    s_xor_b32 s74, s60, 3
    s_lshl_b32 s74, s74, 16
    s_add_u32 s74, s74, s72
    s_add_u32 m0, s67, 12288
    s_add_u32 s63, s74, 0
    buffer_load_dwordx4 v4, s[44:47], s63 offen  lds
    s_add_u32 m0, s67, 13312
    s_add_u32 s63, s74, 16384
    buffer_load_dwordx4 v4, s[44:47], s63 offen  lds
    s_add_u32 m0, s67, 14336
    s_add_u32 s63, s74, 32768
    buffer_load_dwordx4 v4, s[44:47], s63 offen  lds
    s_add_u32 m0, s67, 15360
    s_add_u32 s63, s74, 49152
    buffer_load_dwordx4 v4, s[44:47], s63 offen  lds
    s_waitcnt vmcnt(8)
    ds_read_b64_tr_b16 a[16:17], v6 offset:4096
    ds_read_b64_tr_b16 a[18:19], v6 offset:5120
    ds_read_b64_tr_b16 a[20:21], v6 offset:6144
    ds_read_b64_tr_b16 a[22:23], v6 offset:7168
    ds_read_b64_tr_b16 a[24:25], v6 offset:4104
    ds_read_b64_tr_b16 a[26:27], v6 offset:5128
    ds_read_b64_tr_b16 a[28:29], v6 offset:6152
    ds_read_b64_tr_b16 a[30:31], v6 offset:7176
    s_waitcnt lgkmcnt(8)
    s_xor_b32 s74, s60, 4
    s_lshl_b32 s74, s74, 16
    s_add_u32 s74, s74, s72
    s_add_u32 m0, s67, 0
    s_add_u32 s63, s74, 0
    buffer_load_dwordx4 v4, s[44:47], s63 offen  lds
    s_add_u32 m0, s67, 1024
    s_add_u32 s63, s74, 16384
    buffer_load_dwordx4 v4, s[44:47], s63 offen  lds
    s_add_u32 m0, s67, 2048
    s_add_u32 s63, s74, 32768
    buffer_load_dwordx4 v4, s[44:47], s63 offen  lds
    s_add_u32 m0, s67, 3072
    s_add_u32 s63, s74, 49152
    buffer_load_dwordx4 v4, s[44:47], s63 offen  lds
    s_waitcnt vmcnt(8)
    ds_read_b64_tr_b16 a[32:33], v6 offset:8192
    ds_read_b64_tr_b16 a[34:35], v6 offset:9216
    ds_read_b64_tr_b16 a[36:37], v6 offset:10240
    ds_read_b64_tr_b16 a[38:39], v6 offset:11264
    ds_read_b64_tr_b16 a[40:41], v6 offset:8200
    ds_read_b64_tr_b16 a[42:43], v6 offset:9224
    ds_read_b64_tr_b16 a[44:45], v6 offset:10248
    ds_read_b64_tr_b16 a[46:47], v6 offset:11272
    s_waitcnt lgkmcnt(8)
    s_xor_b32 s74, s60, 5
    s_lshl_b32 s74, s74, 16
    s_add_u32 s74, s74, s72
    s_add_u32 m0, s67, 4096
    s_add_u32 s63, s74, 0
    buffer_load_dwordx4 v4, s[44:47], s63 offen  lds
    s_add_u32 m0, s67, 5120
    s_add_u32 s63, s74, 16384
    buffer_load_dwordx4 v4, s[44:47], s63 offen  lds
    s_add_u32 m0, s67, 6144
    s_add_u32 s63, s74, 32768
    buffer_load_dwordx4 v4, s[44:47], s63 offen  lds
    s_add_u32 m0, s67, 7168
    s_add_u32 s63, s74, 49152
    buffer_load_dwordx4 v4, s[44:47], s63 offen  lds
    s_waitcnt vmcnt(8)
    ds_read_b64_tr_b16 a[48:49], v6 offset:12288
    ds_read_b64_tr_b16 a[50:51], v6 offset:13312
    ds_read_b64_tr_b16 a[52:53], v6 offset:14336
    ds_read_b64_tr_b16 a[54:55], v6 offset:15360
    ds_read_b64_tr_b16 a[56:57], v6 offset:12296
    ds_read_b64_tr_b16 a[58:59], v6 offset:13320
    ds_read_b64_tr_b16 a[60:61], v6 offset:14344
    ds_read_b64_tr_b16 a[62:63], v6 offset:15368
    s_waitcnt lgkmcnt(8)
    s_xor_b32 s74, s60, 6
    s_lshl_b32 s74, s74, 16
    s_add_u32 s74, s74, s72
    s_add_u32 m0, s67, 8192
    s_add_u32 s63, s74, 0
    buffer_load_dwordx4 v4, s[44:47], s63 offen  lds
    s_add_u32 m0, s67, 9216
    s_add_u32 s63, s74, 16384
    buffer_load_dwordx4 v4, s[44:47], s63 offen  lds
    s_add_u32 m0, s67, 10240
    s_add_u32 s63, s74, 32768
    buffer_load_dwordx4 v4, s[44:47], s63 offen  lds
    s_add_u32 m0, s67, 11264
    s_add_u32 s63, s74, 49152
    buffer_load_dwordx4 v4, s[44:47], s63 offen  lds
    s_waitcnt vmcnt(8)
    ds_read_b64_tr_b16 a[64:65], v6 offset:0
    ds_read_b64_tr_b16 a[66:67], v6 offset:1024
    ds_read_b64_tr_b16 a[68:69], v6 offset:2048
    ds_read_b64_tr_b16 a[70:71], v6 offset:3072
    ds_read_b64_tr_b16 a[72:73], v6 offset:8
    ds_read_b64_tr_b16 a[74:75], v6 offset:1032
    ds_read_b64_tr_b16 a[76:77], v6 offset:2056
    ds_read_b64_tr_b16 a[78:79], v6 offset:3080
    s_waitcnt lgkmcnt(8)
    s_xor_b32 s74, s60, 7
    s_lshl_b32 s74, s74, 16
    s_add_u32 s74, s74, s72
    s_add_u32 m0, s67, 12288
    s_add_u32 s63, s74, 0
    buffer_load_dwordx4 v4, s[44:47], s63 offen  lds
    s_add_u32 m0, s67, 13312
    s_add_u32 s63, s74, 16384
    buffer_load_dwordx4 v4, s[44:47], s63 offen  lds
    s_add_u32 m0, s67, 14336
    s_add_u32 s63, s74, 32768
    buffer_load_dwordx4 v4, s[44:47], s63 offen  lds
    s_add_u32 m0, s67, 15360
    s_add_u32 s63, s74, 49152
    buffer_load_dwordx4 v4, s[44:47], s63 offen  lds
    s_waitcnt vmcnt(8)
    ds_read_b64_tr_b16 a[80:81], v6 offset:4096
    ds_read_b64_tr_b16 a[82:83], v6 offset:5120
    ds_read_b64_tr_b16 a[84:85], v6 offset:6144
    ds_read_b64_tr_b16 a[86:87], v6 offset:7168
    ds_read_b64_tr_b16 a[88:89], v6 offset:4104
    ds_read_b64_tr_b16 a[90:91], v6 offset:5128
    ds_read_b64_tr_b16 a[92:93], v6 offset:6152
    ds_read_b64_tr_b16 a[94:95], v6 offset:7176
    s_waitcnt lgkmcnt(8)
    s_xor_b32 s74, s60, 8
    s_lshl_b32 s74, s74, 16
    s_add_u32 s74, s74, s72
    s_add_u32 m0, s67, 0
    s_add_u32 s63, s74, 0
    buffer_load_dwordx4 v4, s[44:47], s63 offen  lds
    s_add_u32 m0, s67, 1024
    s_add_u32 s63, s74, 16384
    buffer_load_dwordx4 v4, s[44:47], s63 offen  lds
    s_add_u32 m0, s67, 2048
    s_add_u32 s63, s74, 32768
    buffer_load_dwordx4 v4, s[44:47], s63 offen  lds
    s_add_u32 m0, s67, 3072
    s_add_u32 s63, s74, 49152
    buffer_load_dwordx4 v4, s[44:47], s63 offen  lds
    s_waitcnt vmcnt(8)
    ds_read_b64_tr_b16 a[96:97], v6 offset:8192
    ds_read_b64_tr_b16 a[98:99], v6 offset:9216
    ds_read_b64_tr_b16 a[100:101], v6 offset:10240
    ds_read_b64_tr_b16 a[102:103], v6 offset:11264
    ds_read_b64_tr_b16 a[104:105], v6 offset:8200
    ds_read_b64_tr_b16 a[106:107], v6 offset:9224
    ds_read_b64_tr_b16 a[108:109], v6 offset:10248
    ds_read_b64_tr_b16 a[110:111], v6 offset:11272
    s_waitcnt lgkmcnt(8)
    s_xor_b32 s74, s60, 9
    s_lshl_b32 s74, s74, 16
    s_add_u32 s74, s74, s72
    s_add_u32 m0, s67, 4096
    s_add_u32 s63, s74, 0
    buffer_load_dwordx4 v4, s[44:47], s63 offen  lds
    s_add_u32 m0, s67, 5120
    s_add_u32 s63, s74, 16384
    buffer_load_dwordx4 v4, s[44:47], s63 offen  lds
    s_add_u32 m0, s67, 6144
    s_add_u32 s63, s74, 32768
    buffer_load_dwordx4 v4, s[44:47], s63 offen  lds
    s_add_u32 m0, s67, 7168
    s_add_u32 s63, s74, 49152
    buffer_load_dwordx4 v4, s[44:47], s63 offen  lds
    s_waitcnt vmcnt(8)
    ds_read_b64_tr_b16 a[112:113], v6 offset:12288
    ds_read_b64_tr_b16 a[114:115], v6 offset:13312
    ds_read_b64_tr_b16 a[116:117], v6 offset:14336
    ds_read_b64_tr_b16 a[118:119], v6 offset:15360
    ds_read_b64_tr_b16 a[120:121], v6 offset:12296
    ds_read_b64_tr_b16 a[122:123], v6 offset:13320
    ds_read_b64_tr_b16 a[124:125], v6 offset:14344
    ds_read_b64_tr_b16 a[126:127], v6 offset:15368
    s_waitcnt lgkmcnt(8)
    s_xor_b32 s74, s60, 10
    s_lshl_b32 s74, s74, 16
    s_add_u32 s74, s74, s72
    s_add_u32 m0, s67, 8192
    s_add_u32 s63, s74, 0
    buffer_load_dwordx4 v4, s[44:47], s63 offen  lds
    s_add_u32 m0, s67, 9216
    s_add_u32 s63, s74, 16384
    buffer_load_dwordx4 v4, s[44:47], s63 offen  lds
    s_add_u32 m0, s67, 10240
    s_add_u32 s63, s74, 32768
    buffer_load_dwordx4 v4, s[44:47], s63 offen  lds
    s_add_u32 m0, s67, 11264
    s_add_u32 s63, s74, 49152
    buffer_load_dwordx4 v4, s[44:47], s63 offen  lds
    s_waitcnt vmcnt(8)
    ds_read_b64_tr_b16 a[128:129], v6 offset:0
    ds_read_b64_tr_b16 a[130:131], v6 offset:1024
    ds_read_b64_tr_b16 a[132:133], v6 offset:2048
    ds_read_b64_tr_b16 a[134:135], v6 offset:3072
    ds_read_b64_tr_b16 a[136:137], v6 offset:8
    ds_read_b64_tr_b16 a[138:139], v6 offset:1032
    ds_read_b64_tr_b16 a[140:141], v6 offset:2056
    ds_read_b64_tr_b16 a[142:143], v6 offset:3080
    s_waitcnt lgkmcnt(8)
    s_xor_b32 s74, s60, 11
    s_lshl_b32 s74, s74, 16
    s_add_u32 s74, s74, s72
    s_add_u32 m0, s67, 12288
    s_add_u32 s63, s74, 0
    buffer_load_dwordx4 v4, s[44:47], s63 offen  lds
    s_add_u32 m0, s67, 13312
    s_add_u32 s63, s74, 16384
    buffer_load_dwordx4 v4, s[44:47], s63 offen  lds
    s_add_u32 m0, s67, 14336
    s_add_u32 s63, s74, 32768
    buffer_load_dwordx4 v4, s[44:47], s63 offen  lds
    s_add_u32 m0, s67, 15360
    s_add_u32 s63, s74, 49152
    buffer_load_dwordx4 v4, s[44:47], s63 offen  lds
    s_waitcnt vmcnt(8)
    ds_read_b64_tr_b16 a[144:145], v6 offset:4096
    ds_read_b64_tr_b16 a[146:147], v6 offset:5120
    ds_read_b64_tr_b16 a[148:149], v6 offset:6144
    ds_read_b64_tr_b16 a[150:151], v6 offset:7168
    ds_read_b64_tr_b16 a[152:153], v6 offset:4104
    ds_read_b64_tr_b16 a[154:155], v6 offset:5128
    ds_read_b64_tr_b16 a[156:157], v6 offset:6152
    ds_read_b64_tr_b16 a[158:159], v6 offset:7176
    s_waitcnt lgkmcnt(8)
    s_xor_b32 s74, s60, 12
    s_lshl_b32 s74, s74, 16
    s_add_u32 s74, s74, s72
    s_add_u32 m0, s67, 0
    s_add_u32 s63, s74, 0
    buffer_load_dwordx4 v4, s[44:47], s63 offen  lds
    s_add_u32 m0, s67, 1024
    s_add_u32 s63, s74, 16384
    buffer_load_dwordx4 v4, s[44:47], s63 offen  lds
    s_add_u32 m0, s67, 2048
    s_add_u32 s63, s74, 32768
    buffer_load_dwordx4 v4, s[44:47], s63 offen  lds
    s_add_u32 m0, s67, 3072
    s_add_u32 s63, s74, 49152
    buffer_load_dwordx4 v4, s[44:47], s63 offen  lds
    s_waitcnt vmcnt(8)
    ds_read_b64_tr_b16 a[160:161], v6 offset:8192
    ds_read_b64_tr_b16 a[162:163], v6 offset:9216
    ds_read_b64_tr_b16 a[164:165], v6 offset:10240
    ds_read_b64_tr_b16 a[166:167], v6 offset:11264
    ds_read_b64_tr_b16 a[168:169], v6 offset:8200
    ds_read_b64_tr_b16 a[170:171], v6 offset:9224
    ds_read_b64_tr_b16 a[172:173], v6 offset:10248
    ds_read_b64_tr_b16 a[174:175], v6 offset:11272
    s_waitcnt lgkmcnt(8)
    s_xor_b32 s74, s60, 13
    s_lshl_b32 s74, s74, 16
    s_add_u32 s74, s74, s72
    s_add_u32 m0, s67, 4096
    s_add_u32 s63, s74, 0
    buffer_load_dwordx4 v4, s[44:47], s63 offen  lds
    s_add_u32 m0, s67, 5120
    s_add_u32 s63, s74, 16384
    buffer_load_dwordx4 v4, s[44:47], s63 offen  lds
    s_add_u32 m0, s67, 6144
    s_add_u32 s63, s74, 32768
    buffer_load_dwordx4 v4, s[44:47], s63 offen  lds
    s_add_u32 m0, s67, 7168
    s_add_u32 s63, s74, 49152
    buffer_load_dwordx4 v4, s[44:47], s63 offen  lds
    s_waitcnt vmcnt(8)
    ds_read_b64_tr_b16 a[176:177], v6 offset:12288
    ds_read_b64_tr_b16 a[178:179], v6 offset:13312
    ds_read_b64_tr_b16 a[180:181], v6 offset:14336
    ds_read_b64_tr_b16 a[182:183], v6 offset:15360
    ds_read_b64_tr_b16 a[184:185], v6 offset:12296
    ds_read_b64_tr_b16 a[186:187], v6 offset:13320
    ds_read_b64_tr_b16 a[188:189], v6 offset:14344
    ds_read_b64_tr_b16 a[190:191], v6 offset:15368
    s_waitcnt lgkmcnt(8)
    s_xor_b32 s74, s60, 14
    s_lshl_b32 s74, s74, 16
    s_add_u32 s74, s74, s72
    s_add_u32 m0, s67, 8192
    s_add_u32 s63, s74, 0
    buffer_load_dwordx4 v4, s[44:47], s63 offen  lds
    s_add_u32 m0, s67, 9216
    s_add_u32 s63, s74, 16384
    buffer_load_dwordx4 v4, s[44:47], s63 offen  lds
    s_add_u32 m0, s67, 10240
    s_add_u32 s63, s74, 32768
    buffer_load_dwordx4 v4, s[44:47], s63 offen  lds
    s_add_u32 m0, s67, 11264
    s_add_u32 s63, s74, 49152
    buffer_load_dwordx4 v4, s[44:47], s63 offen  lds
    s_waitcnt vmcnt(8)
    ds_read_b64_tr_b16 a[192:193], v6 offset:0
    ds_read_b64_tr_b16 a[194:195], v6 offset:1024
    ds_read_b64_tr_b16 a[196:197], v6 offset:2048
    ds_read_b64_tr_b16 a[198:199], v6 offset:3072
    ds_read_b64_tr_b16 a[200:201], v6 offset:8
    ds_read_b64_tr_b16 a[202:203], v6 offset:1032
    ds_read_b64_tr_b16 a[204:205], v6 offset:2056
    ds_read_b64_tr_b16 a[206:207], v6 offset:3080
    s_waitcnt lgkmcnt(8)
    s_xor_b32 s74, s60, 15
    s_lshl_b32 s74, s74, 16
    s_add_u32 s74, s74, s72
    s_add_u32 m0, s67, 12288
    s_add_u32 s63, s74, 0
    buffer_load_dwordx4 v4, s[44:47], s63 offen  lds
    s_add_u32 m0, s67, 13312
    s_add_u32 s63, s74, 16384
    buffer_load_dwordx4 v4, s[44:47], s63 offen  lds
    s_add_u32 m0, s67, 14336
    s_add_u32 s63, s74, 32768
    buffer_load_dwordx4 v4, s[44:47], s63 offen  lds
    s_add_u32 m0, s67, 15360
    s_add_u32 s63, s74, 49152
    buffer_load_dwordx4 v4, s[44:47], s63 offen  lds
    s_waitcnt vmcnt(8)
    ds_read_b64_tr_b16 a[208:209], v6 offset:4096
    ds_read_b64_tr_b16 a[210:211], v6 offset:5120
    ds_read_b64_tr_b16 a[212:213], v6 offset:6144
    ds_read_b64_tr_b16 a[214:215], v6 offset:7168
    ds_read_b64_tr_b16 a[216:217], v6 offset:4104
    ds_read_b64_tr_b16 a[218:219], v6 offset:5128
    ds_read_b64_tr_b16 a[220:221], v6 offset:6152
    ds_read_b64_tr_b16 a[222:223], v6 offset:7176
    s_waitcnt vmcnt(4)
    ds_read_b64_tr_b16 a[224:225], v6 offset:8192
    ds_read_b64_tr_b16 a[226:227], v6 offset:9216
    ds_read_b64_tr_b16 a[228:229], v6 offset:10240
    ds_read_b64_tr_b16 a[230:231], v6 offset:11264
    ds_read_b64_tr_b16 a[232:233], v6 offset:8200
    ds_read_b64_tr_b16 a[234:235], v6 offset:9224
    ds_read_b64_tr_b16 a[236:237], v6 offset:10248
    ds_read_b64_tr_b16 a[238:239], v6 offset:11272
    s_waitcnt vmcnt(0)
    ds_read_b64_tr_b16 a[240:241], v6 offset:12288
    ds_read_b64_tr_b16 a[242:243], v6 offset:13312
    ds_read_b64_tr_b16 a[244:245], v6 offset:14336
    ds_read_b64_tr_b16 a[246:247], v6 offset:15360
    ds_read_b64_tr_b16 a[248:249], v6 offset:12296
    ds_read_b64_tr_b16 a[250:251], v6 offset:13320
    ds_read_b64_tr_b16 a[252:253], v6 offset:14344
    ds_read_b64_tr_b16 a[254:255], v6 offset:15368
    s_waitcnt lgkmcnt(0)
    s_and_b32 s64, s56, 1
    s_lshl_b32 s65, s64, 4
    v_lshlrev_b32 v30, 2, v2
    v_sub_u32 v30, v3, v30
    v_add_u32 v30, s65, v30
    v_cmp_le_i32 s[8:9], 0, v30
    v_cmp_le_i32 s[16:17], 16, v30
    v_cmp_le_i32 s[10:11], 1, v30
    v_cmp_le_i32 s[18:19], 17, v30
    v_cmp_le_i32 s[12:13], 2, v30
    v_cmp_le_i32 s[20:21], 18, v30
    v_cmp_le_i32 s[14:15], 3, v30
    v_cmp_le_i32 s[22:23], 19, v30
    v_and_b32 v36, 4294967263, v1
    v_or_b32 v41, 32, v1
    v_bfe_u32 v30, v0, 1, 1
    v_lshl_add_u32 v41, v30, 3, v41
    v_mov_b32 v37, 0
    s_lshl_b32 s64, s64, 10
    s_add_u32 s64, s64, 65536
    v_add_u32 v38, s64, v1
    s_lshl_b32 s64, s56, 11
    s_add_u32 s64, s64, 155648
    v_add_u32 v39, s64, v1
    v_add_u32 v40, 155648, v1
    v_mov_b32 v54, 0x3f803f80
    v_mov_b32 v55, 0x3f803f80
    v_mov_b32 v45, 0
    v_mov_b32 v46, 0
    s_mov_b32 s75, s58
    s_mov_b32 s76, s59
    s_mov_b32 s68, 0
    s_mov_b32 s77, 0x3e0293ee
    s_add_u32 s73, s73, 1024
    s_mov_b32 s26, 0
    s_mov_b32 s31, 0
    v_mov_b32 v48, 0
    s_mov_b32 s27, 1
    s_lshl_b32 s24, s57, 7
    s_add_u32 s24, s24, 64032768
    s_lshr_b32 s25, s59, 1
    s_lshl_b32 s25, s25, 12
    s_add_u32 s25, s25, 62914560
    v_mov_b32 v42, 0
    v_mov_b32 v43, 0
    s_lshl_b32 s63, s58, 12
    s_lshl_b32 s64, s57, 7
    s_add_u32 s63, s63, s64
    s_add_u32 s63, s63, 62914560
    s_add_u32 s48, s36, s63
    s_addc_u32 s49, s37, 0
    s_cmp_eq_u32 s56, 0
    s_cselect_b32 s70, 4, 0
    s_lshl_b32 s32, s56, 12
    s_lshl_b32 s71, s57, 14
    s_add_u32 s71, s71, s32
    v_mov_b32 v50, v1
    s_lshr_b32 s63, s56, 1
    s_lshl_b32 s63, s63, 13
    v_add_u32 v51, s63, v1
    s_barrier
    s_add_u32 s63, s75, 0
    s_cmp_ge_u32 s63, 64
    s_cselect_b32 s63, s75, s63
    s_lshl_b32 s63, s63, 19
    s_add_u32 s63, s63, s71
    s_xor_b32 s32, s32, 16384
    s_mov_b32 m0, s32
    s_nop 0
    buffer_load_dwordx4 v1, s[36:39], s63 offen offset:0 sc1 lds
    buffer_load_dwordx4 v1, s[36:39], s63 offen offset:1024 sc1 lds
    buffer_load_dwordx4 v1, s[36:39], s63 offen offset:2048 sc1 lds
    buffer_load_dwordx4 v1, s[36:39], s63 offen offset:3072 sc1 lds
L_EV:
    s_cmp_ge_u32 s75, 64
    s_cbranch_scc1 L_EV_OUT
    s_lshr_b32 s63, s76, 1
    s_sub_u32 s64, s75, 58
    s_cmp_lt_u32 s75, 61
    s_cselect_b32 s64, 5, s64
    s_cmp_lt_u32 s75, 54
    s_cselect_b32 s64, 8, s64
    s_cmp_lt_u32 s75, 48
    s_cselect_b32 s64, 23, s64
    s_add_u32 s63, s63, s64
    s_cmp_gt_u32 s75, s63
    s_cbranch_scc1 L_EV_OUT
    ds_read_b128 v[64:67], v38 offset:0
    ds_read_b128 v[68:71], v38 offset:2048
    ds_read_b128 v[72:75], v38 offset:4096
    ds_read_b128 v[76:79], v38 offset:6144
    v_add_u32 v38, 8192, v38
    v_xor_b32 v50, 16384, v50
    v_xor_b32 v51, 16384, v51
    s_lshl_b32 s28, s75, 17
    s_lshl_b32 s63, s57, 12
    s_add_u32 s28, s28, s63
    s_add_u32 s28, s28, 33685504
    s_lshr_b32 s29, s56, 1
    s_lshl_b32 s29, s29, 11
    s_add_u32 s29, s29, s28
    s_add_u32 s30, s75, 2
    s_cmp_ge_u32 s75, 62
    s_cselect_b32 s30, 62, s30
    v_cmp_gt_u32 vcc, s30, v42
    s_cbranch_vccnz L_AT_SLOW
    buffer_load_dwordx4 v[128:131], v36, s[36:39], s28 offen offset:0 sc1
    buffer_load_dwordx4 v[132:135], v36, s[36:39], s28 offen offset:1024 sc1
    buffer_load_dwordx4 v[136:139], v36, s[36:39], s28 offen offset:2048 sc1
    buffer_load_dwordx4 v[140:143], v36, s[36:39], s28 offen offset:3072 sc1
    buffer_load_dwordx2 v[144:145], v41, s[36:39], s29 offen offset:0 sc1
    buffer_load_dwordx2 v[146:147], v41, s[36:39], s29 offen offset:1024 sc1
    buffer_load_dword v42, v37, s[36:39], s24 offen sc1
    buffer_load_dword v43, v35, s[36:39], s25 offen sc1
    s_waitcnt vmcnt(8)
    s_cmp_lg_u32 s26, s68
    s_cselect_b32 s50, s70, 0
    s_mov_b32 s26, s68
    v_mov_b32 v49, s68
    s_barrier
    buffer_store_dword v49, v1, s[48:51], 0 offen sc1
    s_branch L_AT_GO
L_AT_SLOW:
    s_waitcnt vmcnt(0)
    s_cmp_lg_u32 s26, s68
    s_cselect_b32 s50, s70, 0
    s_mov_b32 s26, s68
    v_mov_b32 v49, s68
    s_barrier
    buffer_store_dword v49, v1, s[48:51], 0 offen sc1
L_poll_25:
    buffer_load_dword v42, v37, s[36:39], s24 offen sc1
    s_sub_u32 s61, s61, 1
    s_cbranch_scc1 L_END
    s_waitcnt vmcnt(0)
    v_cmp_gt_u32 vcc, s30, v42
    s_cbranch_vccz L_polld_26
    s_sleep 1
    s_branch L_poll_25
L_polld_26:
    buffer_load_dwordx4 v[128:131], v36, s[36:39], s28 offen offset:0 sc1
    buffer_load_dwordx4 v[132:135], v36, s[36:39], s28 offen offset:1024 sc1
    buffer_load_dwordx4 v[136:139], v36, s[36:39], s28 offen offset:2048 sc1
    buffer_load_dwordx4 v[140:143], v36, s[36:39], s28 offen offset:3072 sc1
    buffer_load_dwordx2 v[144:145], v41, s[36:39], s29 offen offset:0 sc1
    buffer_load_dwordx2 v[146:147], v41, s[36:39], s29 offen offset:1024 sc1
    buffer_load_dword v42, v37, s[36:39], s24 offen sc1
    buffer_load_dword v43, v35, s[36:39], s25 offen sc1
    buffer_load_dword v42, v37, s[36:39], s24 offen sc1
L_AT_GO:
    ds_read_b128 v[80:83], v50 offset:0
    ds_read_b128 v[84:87], v50 offset:1024
    ds_read_b128 v[88:91], v50 offset:4096
    ds_read_b128 v[92:95], v50 offset:5120
    ds_read_b128 v[96:99], v50 offset:8192
    ds_read_b128 v[100:103], v50 offset:9216
    ds_read_b128 v[104:107], v50 offset:12288
    ds_read_b128 v[108:111], v50 offset:13312
    s_add_u32 s63, s75, 6
    s_cmp_ge_u32 s63, 64
    s_cselect_b32 s63, s75, s63
    s_lshl_b32 s63, s63, 19
    s_add_u32 s63, s63, s71
    s_xor_b32 s32, s32, 16384
    s_mov_b32 m0, s32
    s_nop 0
    buffer_load_dwordx4 v1, s[36:39], s63 offen offset:0 sc1 lds
    buffer_load_dwordx4 v1, s[36:39], s63 offen offset:1024 sc1 lds
    buffer_load_dwordx4 v1, s[36:39], s63 offen offset:2048 sc1 lds
    buffer_load_dwordx4 v1, s[36:39], s63 offen offset:3072 sc1 lds
    s_waitcnt lgkmcnt(0)
    ds_read_b128 v[112:115], v51 offset:2048
    ds_read_b128 v[116:119], v51 offset:3072
    ds_read_b128 v[120:123], v51 offset:6144
    ds_read_b128 v[124:127], v51 offset:7168
    v_mfma_f32_16x16x32_bf16 v[148:151], v[80:83], v[64:67], 0
    v_mfma_f32_16x16x32_bf16 v[152:155], v[84:87], v[64:67], 0
    v_mfma_f32_16x16x32_bf16 v[148:151], v[88:91], v[68:71], v[148:151]
    v_mfma_f32_16x16x32_bf16 v[152:155], v[92:95], v[68:71], v[152:155]
    v_mfma_f32_16x16x32_bf16 v[148:151], v[96:99], v[72:75], v[148:151]
    v_mfma_f32_16x16x32_bf16 v[152:155], v[100:103], v[72:75], v[152:155]
    v_mfma_f32_16x16x32_bf16 v[148:151], v[104:107], v[76:79], v[148:151]
    v_mfma_f32_16x16x32_bf16 v[152:155], v[108:111], v[76:79], v[152:155]
    v_mov_b32 v30, 0xff61b1e6
    s_nop 1
    v_cndmask_b32 v148, v30, v148, s[8:9]
    s_nop 2
    v_cndmask_b32 v152, v30, v152, s[16:17]
    v_cndmask_b32 v149, v30, v149, s[10:11]
    v_cndmask_b32 v153, v30, v153, s[18:19]
    v_cndmask_b32 v150, v30, v150, s[12:13]
    v_cndmask_b32 v154, v30, v154, s[20:21]
    v_cndmask_b32 v151, v30, v151, s[14:15]
    v_cndmask_b32 v155, v30, v155, s[22:23]
    v_max3_f32 v160, v148, v149, v150
    v_max3_f32 v160, v151, v152, v160
    v_max3_f32 v160, v153, v154, v160
    v_max_f32 v160, v155, v160
    s_cmp_lt_u32 s75, 62
    s_cbranch_scc1 L_ZV_OK
L_ZV:
    s_waitcnt vmcnt(0)
    v_max3_u32 v30, v128, v129, v130
    v_max3_u32 v30, v131, v132, v30
    v_max3_u32 v30, v133, v134, v30
    v_max3_u32 v30, v135, v136, v30
    v_max3_u32 v30, v137, v138, v30
    v_max3_u32 v30, v139, v140, v30
    v_max3_u32 v30, v141, v142, v30
    v_max3_u32 v30, v143, v144, v30
    v_max3_u32 v30, v145, v146, v30
    v_max_u32 v30, v147, v30
    v_cmp_eq_u32 vcc, -1, v30
    s_cbranch_vccz L_ZV_OK
    buffer_load_dwordx4 v[128:131], v36, s[36:39], s28 offen offset:0 sc1
    buffer_load_dwordx4 v[132:135], v36, s[36:39], s28 offen offset:1024 sc1
    buffer_load_dwordx4 v[136:139], v36, s[36:39], s28 offen offset:2048 sc1
    buffer_load_dwordx4 v[140:143], v36, s[36:39], s28 offen offset:3072 sc1
    buffer_load_dwordx2 v[144:145], v41, s[36:39], s29 offen offset:0 sc1
    buffer_load_dwordx2 v[146:147], v41, s[36:39], s29 offen offset:1024 sc1
    s_sub_u32 s61, s61, 1
    s_cbranch_scc1 L_END
    s_branch L_ZV
L_ZV_OK:
    s_waitcnt vmcnt(12)
    v_mfma_f32_16x16x32_bf16 v[156:159], v[128:131], v[64:67], 0
    s_waitcnt vmcnt(11)
    v_mfma_f32_16x16x32_bf16 v[156:159], v[132:135], v[68:71], v[156:159]
    s_waitcnt vmcnt(10)
    v_mfma_f32_16x16x32_bf16 v[156:159], v[136:139], v[72:75], v[156:159]
    s_waitcnt vmcnt(9)
    v_mfma_f32_16x16x32_bf16 v[156:159], v[140:143], v[76:79], v[156:159]
    s_lshl_b32 s63, s75, 1
    s_and_b32 s64, s56, 1
    s_add_u32 s63, s63, s64
    s_lshl_b32 s63, s63, 17
    s_lshl_b32 s64, s57, 12
    s_add_u32 s63, s63, s64
    s_lshr_b32 s64, s56, 1
    s_lshl_b32 s64, s64, 11
    s_add_u32 s63, s63, s64
    s_add_u32 s72, s63, 42991616
    v_mul_f32 v156, s77, v156
    v_mul_f32 v157, s77, v157
    v_max3_f32 v160, v156, v157, v160
    v_mov_b32 v161, v160
    s_nop 1
    v_permlane16_swap_b32 v160, v161
    v_max_f32 v160, v160, v161
    v_mov_b32 v161, v160
    s_nop 1
    v_permlane32_swap_b32 v160, v161
    v_max_f32 v160, v160, v161
    v_sub_f32 v148, v148, v160
    v_sub_f32 v149, v149, v160
    v_sub_f32 v150, v150, v160
    v_sub_f32 v151, v151, v160
    v_sub_f32 v152, v152, v160
    v_sub_f32 v153, v153, v160
    v_sub_f32 v154, v154, v160
    v_sub_f32 v155, v155, v160
    v_sub_f32 v156, v156, v160
    v_sub_f32 v157, v157, v160
    v_exp_f32 v148, v148
    v_exp_f32 v149, v149
    v_exp_f32 v150, v150
    v_exp_f32 v151, v151
    v_exp_f32 v152, v152
    v_exp_f32 v153, v153
    v_exp_f32 v154, v154
    v_exp_f32 v155, v155
    v_exp_f32 v156, v156
    v_exp_f32 v157, v157
    v_cvt_pk_bf16_f32 v164, v148, v149
    v_cvt_pk_bf16_f32 v165, v150, v151
    v_cvt_pk_bf16_f32 v166, v152, v153
    v_cvt_pk_bf16_f32 v167, v154, v155
    v_cvt_pk_bf16_f32 v44, v156, v157
    v_cvt_pk_bf16_f32 v47, v156, v157
    s_waitcnt lgkmcnt(0)
    v_mfma_f32_16x16x32_bf16 v[160:163], v[52:55], v[164:167], 0
    v_mfma_f32_16x16x32_bf16 v[168:171], v[112:115], v[164:167], 0
    v_mfma_f32_16x16x32_bf16 v[172:175], v[116:119], v[164:167], 0
    v_mfma_f32_16x16x32_bf16 v[176:179], v[120:123], v[164:167], 0
    v_mfma_f32_16x16x32_bf16 v[180:183], v[124:127], v[164:167], 0
    s_waitcnt vmcnt(7)
    v_mfma_f32_16x16x16_bf16 v[160:163], v[52:53], v[44:45], v[160:163]
    v_mfma_f32_16x16x16_bf16 v[168:171], v[144:145], v[44:45], v[168:171]
    v_mfma_f32_16x16x16_bf16 v[172:175], v[144:145], v[46:47], v[172:175]
    v_mfma_f32_16x16x16_bf16 v[176:179], v[146:147], v[44:45], v[176:179]
    v_mfma_f32_16x16x16_bf16 v[180:183], v[146:147], v[46:47], v[180:183]
    v_rcp_f32 v160, v160
    s_nop 0
    v_mul_f32 v168, v160, v168
    v_mul_f32 v169, v160, v169
    v_mul_f32 v170, v160, v170
    v_mul_f32 v171, v160, v171
    v_mul_f32 v172, v160, v172
    v_mul_f32 v173, v160, v173
    v_mul_f32 v174, v160, v174
    v_mul_f32 v175, v160, v175
    v_cvt_pk_bf16_f32 v148, v168, v169
    v_cvt_pk_bf16_f32 v149, v170, v171
    v_cvt_pk_bf16_f32 v150, v172, v173
    v_cvt_pk_bf16_f32 v151, v174, v175
    buffer_store_dwordx4 v[148:151], v1, s[36:39], s72 offen offset:0 sc1
    v_mul_f32 v176, v160, v176
    v_mul_f32 v177, v160, v177
    v_mul_f32 v178, v160, v178
    v_mul_f32 v179, v160, v179
    v_mul_f32 v180, v160, v180
    v_mul_f32 v181, v160, v181
    v_mul_f32 v182, v160, v182
    v_mul_f32 v183, v160, v183
    v_cvt_pk_bf16_f32 v152, v176, v177
    v_cvt_pk_bf16_f32 v153, v178, v179
    v_cvt_pk_bf16_f32 v154, v180, v181
    v_cvt_pk_bf16_f32 v155, v182, v183
    buffer_store_dwordx4 v[152:155], v1, s[36:39], s72 offen offset:1024 sc1
    s_add_u32 s68, s68, 1
    s_add_u32 s75, s75, 6
    s_branch L_EV
L_EV_OUT:
    s_lshl_b32 s28, s76, 17
    s_lshl_b32 s63, s56, 15
    s_add_u32 s28, s28, s63
    s_lshl_b32 s63, s60, 11
    s_add_u32 s28, s28, s63
    s_add_u32 s28, s28, 42991616
    v_cmp_gt_u32 vcc, s27, v43
    s_cmp_ge_u32 s75, 60
    s_cbranch_scc1 L_OUT_SLOW
    s_cbranch_vccnz L_OUT_SLOW
    s_xor_b32 s63, s28, 0
    buffer_load_dwordx4 v[128:131], v1, s[36:39], s63 offen offset:0 sc1
    buffer_load_dwordx4 v[132:135], v1, s[36:39], s63 offen offset:1024 sc1
    s_xor_b32 s63, s28, 2048
    buffer_load_dwordx4 v[136:139], v1, s[36:39], s63 offen offset:0 sc1
    buffer_load_dwordx4 v[140:143], v1, s[36:39], s63 offen offset:1024 sc1
    s_xor_b32 s63, s28, 4096
    buffer_load_dwordx4 v[144:147], v1, s[36:39], s63 offen offset:0 sc1
    buffer_load_dwordx4 v[148:151], v1, s[36:39], s63 offen offset:1024 sc1
    s_xor_b32 s63, s28, 6144
    buffer_load_dwordx4 v[152:155], v1, s[36:39], s63 offen offset:0 sc1
    buffer_load_dwordx4 v[156:159], v1, s[36:39], s63 offen offset:1024 sc1
    s_xor_b32 s63, s28, 8192
    buffer_load_dwordx4 v[160:163], v1, s[36:39], s63 offen offset:0 sc1
    buffer_load_dwordx4 v[164:167], v1, s[36:39], s63 offen offset:1024 sc1
    s_xor_b32 s63, s28, 10240
    buffer_load_dwordx4 v[168:171], v1, s[36:39], s63 offen offset:0 sc1
    buffer_load_dwordx4 v[172:175], v1, s[36:39], s63 offen offset:1024 sc1
    s_xor_b32 s63, s28, 12288
    buffer_load_dwordx4 v[176:179], v1, s[36:39], s63 offen offset:0 sc1
    buffer_load_dwordx4 v[180:183], v1, s[36:39], s63 offen offset:1024 sc1
    s_xor_b32 s63, s28, 14336
    buffer_load_dwordx4 v[184:187], v1, s[36:39], s63 offen offset:0 sc1
    buffer_load_dwordx4 v[188:191], v1, s[36:39], s63 offen offset:1024 sc1
    s_xor_b32 s63, s28, 16384
    buffer_load_dwordx4 v[192:195], v1, s[36:39], s63 offen offset:0 sc1
    buffer_load_dwordx4 v[196:199], v1, s[36:39], s63 offen offset:1024 sc1
    s_xor_b32 s63, s28, 18432
    buffer_load_dwordx4 v[200:203], v1, s[36:39], s63 offen offset:0 sc1
    buffer_load_dwordx4 v[204:207], v1, s[36:39], s63 offen offset:1024 sc1
    s_xor_b32 s63, s28, 20480
    buffer_load_dwordx4 v[208:211], v1, s[36:39], s63 offen offset:0 sc1
    buffer_load_dwordx4 v[212:215], v1, s[36:39], s63 offen offset:1024 sc1
    s_xor_b32 s63, s28, 22528
    buffer_load_dwordx4 v[216:219], v1, s[36:39], s63 offen offset:0 sc1
    buffer_load_dwordx4 v[220:223], v1, s[36:39], s63 offen offset:1024 sc1
    s_xor_b32 s63, s28, 24576
    buffer_load_dwordx4 v[224:227], v1, s[36:39], s63 offen offset:0 sc1
    buffer_load_dwordx4 v[228:231], v1, s[36:39], s63 offen offset:1024 sc1
    s_xor_b32 s63, s28, 26624
    buffer_load_dwordx4 v[232:235], v1, s[36:39], s63 offen offset:0 sc1
    buffer_load_dwordx4 v[236:239], v1, s[36:39], s63 offen offset:1024 sc1
    s_xor_b32 s63, s28, 28672
    buffer_load_dwordx4 v[240:243], v1, s[36:39], s63 offen offset:0 sc1
    buffer_load_dwordx4 v[244:247], v1, s[36:39], s63 offen offset:1024 sc1
    s_xor_b32 s63, s28, 30720
    buffer_load_dwordx4 v[248:251], v1, s[36:39], s63 offen offset:0 sc1
    buffer_load_dwordx4 v[252:255], v1, s[36:39], s63 offen offset:1024 sc1
    buffer_load_dword v42, v37, s[36:39], s24 offen sc1
    buffer_load_dword v43, v35, s[36:39], s25 offen sc1
    s_waitcnt vmcnt(34)
    s_cmp_lg_u32 s26, s68
    s_cselect_b32 s50, s70, 0
    s_mov_b32 s26, s68
    v_mov_b32 v49, s68
    s_barrier
    buffer_store_dword v49, v1, s[48:51], 0 offen sc1
    s_branch L_OUT_GO
L_OUT_SLOW:
    s_waitcnt vmcnt(0)
    s_cmp_lg_u32 s26, s68
    s_cselect_b32 s50, s70, 0
    s_mov_b32 s26, s68
    v_mov_b32 v49, s68
    s_barrier
    buffer_store_dword v49, v1, s[48:51], 0 offen sc1
    s_cmp_ge_u32 s76, 128
    s_cbranch_scc1 L_END
    s_cmp_ge_u32 s75, 60
    s_cbranch_scc1 L_OUT_ONE
L_poll_27:
    buffer_load_dword v43, v35, s[36:39], s25 offen sc1
    s_sub_u32 s61, s61, 1
    s_cbranch_scc1 L_END
    s_waitcnt vmcnt(0)
    v_cmp_gt_u32 vcc, s27, v43
    s_cbranch_vccz L_polld_28
    s_sleep 4
    s_branch L_poll_27
L_polld_28:
    s_branch L_OUT_LD
L_OUT_ONE:
    s_cmp_lg_u32 s56, 0
    s_cbranch_scc1 L_polld_30
L_poll_29:
    buffer_load_dword v43, v35, s[36:39], s25 offen sc1
    s_sub_u32 s61, s61, 1
    s_cbranch_scc1 L_END
    s_waitcnt vmcnt(0)
    v_cmp_gt_u32 vcc, s27, v43
    s_cbranch_vccz L_polld_30
    s_sleep 1
    s_branch L_poll_29
L_polld_30:
    s_barrier
L_OUT_LD:
    s_xor_b32 s63, s28, 0
    buffer_load_dwordx4 v[128:131], v1, s[36:39], s63 offen offset:0 sc1
    buffer_load_dwordx4 v[132:135], v1, s[36:39], s63 offen offset:1024 sc1
    s_xor_b32 s63, s28, 2048
    buffer_load_dwordx4 v[136:139], v1, s[36:39], s63 offen offset:0 sc1
    buffer_load_dwordx4 v[140:143], v1, s[36:39], s63 offen offset:1024 sc1
    s_xor_b32 s63, s28, 4096
    buffer_load_dwordx4 v[144:147], v1, s[36:39], s63 offen offset:0 sc1
    buffer_load_dwordx4 v[148:151], v1, s[36:39], s63 offen offset:1024 sc1
    s_xor_b32 s63, s28, 6144
    buffer_load_dwordx4 v[152:155], v1, s[36:39], s63 offen offset:0 sc1
    buffer_load_dwordx4 v[156:159], v1, s[36:39], s63 offen offset:1024 sc1
    s_xor_b32 s63, s28, 8192
    buffer_load_dwordx4 v[160:163], v1, s[36:39], s63 offen offset:0 sc1
    buffer_load_dwordx4 v[164:167], v1, s[36:39], s63 offen offset:1024 sc1
    s_xor_b32 s63, s28, 10240
    buffer_load_dwordx4 v[168:171], v1, s[36:39], s63 offen offset:0 sc1
    buffer_load_dwordx4 v[172:175], v1, s[36:39], s63 offen offset:1024 sc1
    s_xor_b32 s63, s28, 12288
    buffer_load_dwordx4 v[176:179], v1, s[36:39], s63 offen offset:0 sc1
    buffer_load_dwordx4 v[180:183], v1, s[36:39], s63 offen offset:1024 sc1
    s_xor_b32 s63, s28, 14336
    buffer_load_dwordx4 v[184:187], v1, s[36:39], s63 offen offset:0 sc1
    buffer_load_dwordx4 v[188:191], v1, s[36:39], s63 offen offset:1024 sc1
    s_xor_b32 s63, s28, 16384
    buffer_load_dwordx4 v[192:195], v1, s[36:39], s63 offen offset:0 sc1
    buffer_load_dwordx4 v[196:199], v1, s[36:39], s63 offen offset:1024 sc1
    s_xor_b32 s63, s28, 18432
    buffer_load_dwordx4 v[200:203], v1, s[36:39], s63 offen offset:0 sc1
    buffer_load_dwordx4 v[204:207], v1, s[36:39], s63 offen offset:1024 sc1
    s_xor_b32 s63, s28, 20480
    buffer_load_dwordx4 v[208:211], v1, s[36:39], s63 offen offset:0 sc1
    buffer_load_dwordx4 v[212:215], v1, s[36:39], s63 offen offset:1024 sc1
    s_xor_b32 s63, s28, 22528
    buffer_load_dwordx4 v[216:219], v1, s[36:39], s63 offen offset:0 sc1
    buffer_load_dwordx4 v[220:223], v1, s[36:39], s63 offen offset:1024 sc1
    s_xor_b32 s63, s28, 24576
    buffer_load_dwordx4 v[224:227], v1, s[36:39], s63 offen offset:0 sc1
    buffer_load_dwordx4 v[228:231], v1, s[36:39], s63 offen offset:1024 sc1
    s_xor_b32 s63, s28, 26624
    buffer_load_dwordx4 v[232:235], v1, s[36:39], s63 offen offset:0 sc1
    buffer_load_dwordx4 v[236:239], v1, s[36:39], s63 offen offset:1024 sc1
    s_xor_b32 s63, s28, 28672
    buffer_load_dwordx4 v[240:243], v1, s[36:39], s63 offen offset:0 sc1
    buffer_load_dwordx4 v[244:247], v1, s[36:39], s63 offen offset:1024 sc1
    s_xor_b32 s63, s28, 30720
    buffer_load_dwordx4 v[248:251], v1, s[36:39], s63 offen offset:0 sc1
    buffer_load_dwordx4 v[252:255], v1, s[36:39], s63 offen offset:1024 sc1
    buffer_load_dword v42, v37, s[36:39], s24 offen sc1
    buffer_load_dword v43, v35, s[36:39], s25 offen sc1
    buffer_load_dword v42, v37, s[36:39], s24 offen sc1
L_OUT_GO:
    s_waitcnt vmcnt(34)
    v_mfma_f32_16x16x32_bf16 v[56:59], a[0:3], v[128:131], 0
    v_mfma_f32_16x16x32_bf16 v[60:63], a[8:11], v[128:131], 0
    s_waitcnt vmcnt(33)
    v_mfma_f32_16x16x32_bf16 v[56:59], a[4:7], v[132:135], v[56:59]
    v_mfma_f32_16x16x32_bf16 v[60:63], a[12:15], v[132:135], v[60:63]
    s_waitcnt vmcnt(32)
    v_mfma_f32_16x16x32_bf16 v[56:59], a[16:19], v[136:139], v[56:59]
    v_mfma_f32_16x16x32_bf16 v[60:63], a[24:27], v[136:139], v[60:63]
    s_waitcnt vmcnt(31)
    v_mfma_f32_16x16x32_bf16 v[56:59], a[20:23], v[140:143], v[56:59]
    v_mfma_f32_16x16x32_bf16 v[60:63], a[28:31], v[140:143], v[60:63]
    s_waitcnt vmcnt(30)
    v_mfma_f32_16x16x32_bf16 v[56:59], a[32:35], v[144:147], v[56:59]
    v_mfma_f32_16x16x32_bf16 v[60:63], a[40:43], v[144:147], v[60:63]
    s_waitcnt vmcnt(29)
    v_mfma_f32_16x16x32_bf16 v[56:59], a[36:39], v[148:151], v[56:59]
    v_mfma_f32_16x16x32_bf16 v[60:63], a[44:47], v[148:151], v[60:63]
    s_waitcnt vmcnt(28)
    v_mfma_f32_16x16x32_bf16 v[56:59], a[48:51], v[152:155], v[56:59]
    v_mfma_f32_16x16x32_bf16 v[60:63], a[56:59], v[152:155], v[60:63]
    s_waitcnt vmcnt(27)
    v_mfma_f32_16x16x32_bf16 v[56:59], a[52:55], v[156:159], v[56:59]
    v_mfma_f32_16x16x32_bf16 v[60:63], a[60:63], v[156:159], v[60:63]
    s_waitcnt vmcnt(26)
    v_mfma_f32_16x16x32_bf16 v[56:59], a[64:67], v[160:163], v[56:59]
    v_mfma_f32_16x16x32_bf16 v[60:63], a[72:75], v[160:163], v[60:63]
    s_waitcnt vmcnt(25)
    v_mfma_f32_16x16x32_bf16 v[56:59], a[68:71], v[164:167], v[56:59]
    v_mfma_f32_16x16x32_bf16 v[60:63], a[76:79], v[164:167], v[60:63]
    s_waitcnt vmcnt(24)
    v_mfma_f32_16x16x32_bf16 v[56:59], a[80:83], v[168:171], v[56:59]
    v_mfma_f32_16x16x32_bf16 v[60:63], a[88:91], v[168:171], v[60:63]
    s_waitcnt vmcnt(23)
    v_mfma_f32_16x16x32_bf16 v[56:59], a[84:87], v[172:175], v[56:59]
    v_mfma_f32_16x16x32_bf16 v[60:63], a[92:95], v[172:175], v[60:63]
    s_waitcnt vmcnt(22)
    v_mfma_f32_16x16x32_bf16 v[56:59], a[96:99], v[176:179], v[56:59]
    v_mfma_f32_16x16x32_bf16 v[60:63], a[104:107], v[176:179], v[60:63]
    s_waitcnt vmcnt(21)
    v_mfma_f32_16x16x32_bf16 v[56:59], a[100:103], v[180:183], v[56:59]
    v_mfma_f32_16x16x32_bf16 v[60:63], a[108:111], v[180:183], v[60:63]
    s_waitcnt vmcnt(20)
    v_mfma_f32_16x16x32_bf16 v[56:59], a[112:115], v[184:187], v[56:59]
    v_mfma_f32_16x16x32_bf16 v[60:63], a[120:123], v[184:187], v[60:63]
    s_waitcnt vmcnt(19)
    v_mfma_f32_16x16x32_bf16 v[56:59], a[116:119], v[188:191], v[56:59]
    v_mfma_f32_16x16x32_bf16 v[60:63], a[124:127], v[188:191], v[60:63]
    s_waitcnt vmcnt(18)
    v_mfma_f32_16x16x32_bf16 v[56:59], a[128:131], v[192:195], v[56:59]
    v_mfma_f32_16x16x32_bf16 v[60:63], a[136:139], v[192:195], v[60:63]
    s_waitcnt vmcnt(17)
    v_mfma_f32_16x16x32_bf16 v[56:59], a[132:135], v[196:199], v[56:59]
    v_mfma_f32_16x16x32_bf16 v[60:63], a[140:143], v[196:199], v[60:63]
    s_waitcnt vmcnt(16)
    v_mfma_f32_16x16x32_bf16 v[56:59], a[144:147], v[200:203], v[56:59]
    v_mfma_f32_16x16x32_bf16 v[60:63], a[152:155], v[200:203], v[60:63]
    s_waitcnt vmcnt(15)
    v_mfma_f32_16x16x32_bf16 v[56:59], a[148:151], v[204:207], v[56:59]
    v_mfma_f32_16x16x32_bf16 v[60:63], a[156:159], v[204:207], v[60:63]
    s_waitcnt vmcnt(14)
    v_mfma_f32_16x16x32_bf16 v[56:59], a[160:163], v[208:211], v[56:59]
    v_mfma_f32_16x16x32_bf16 v[60:63], a[168:171], v[208:211], v[60:63]
    s_waitcnt vmcnt(13)
    v_mfma_f32_16x16x32_bf16 v[56:59], a[164:167], v[212:215], v[56:59]
    v_mfma_f32_16x16x32_bf16 v[60:63], a[172:175], v[212:215], v[60:63]
    s_waitcnt vmcnt(12)
    v_mfma_f32_16x16x32_bf16 v[56:59], a[176:179], v[216:219], v[56:59]
    v_mfma_f32_16x16x32_bf16 v[60:63], a[184:187], v[216:219], v[60:63]
    s_waitcnt vmcnt(11)
    v_mfma_f32_16x16x32_bf16 v[56:59], a[180:183], v[220:223], v[56:59]
    v_mfma_f32_16x16x32_bf16 v[60:63], a[188:191], v[220:223], v[60:63]
    s_waitcnt vmcnt(10)
    v_mfma_f32_16x16x32_bf16 v[56:59], a[192:195], v[224:227], v[56:59]
    v_mfma_f32_16x16x32_bf16 v[60:63], a[200:203], v[224:227], v[60:63]
    s_waitcnt vmcnt(9)
    v_mfma_f32_16x16x32_bf16 v[56:59], a[196:199], v[228:231], v[56:59]
    v_mfma_f32_16x16x32_bf16 v[60:63], a[204:207], v[228:231], v[60:63]
    s_waitcnt vmcnt(8)
    v_mfma_f32_16x16x32_bf16 v[56:59], a[208:211], v[232:235], v[56:59]
    v_mfma_f32_16x16x32_bf16 v[60:63], a[216:219], v[232:235], v[60:63]
    s_waitcnt vmcnt(7)
    v_mfma_f32_16x16x32_bf16 v[56:59], a[212:215], v[236:239], v[56:59]
    v_mfma_f32_16x16x32_bf16 v[60:63], a[220:223], v[236:239], v[60:63]
    s_waitcnt vmcnt(6)
    v_mfma_f32_16x16x32_bf16 v[56:59], a[224:227], v[240:243], v[56:59]
    v_mfma_f32_16x16x32_bf16 v[60:63], a[232:235], v[240:243], v[60:63]
    s_waitcnt vmcnt(5)
    v_mfma_f32_16x16x32_bf16 v[56:59], a[228:231], v[244:247], v[56:59]
    v_mfma_f32_16x16x32_bf16 v[60:63], a[236:239], v[244:247], v[60:63]
    s_waitcnt vmcnt(4)
    v_mfma_f32_16x16x32_bf16 v[56:59], a[240:243], v[248:251], v[56:59]
    v_mfma_f32_16x16x32_bf16 v[60:63], a[248:251], v[248:251], v[60:63]
    s_waitcnt vmcnt(3)
    v_mfma_f32_16x16x32_bf16 v[56:59], a[244:247], v[252:255], v[56:59]
    v_mfma_f32_16x16x32_bf16 v[60:63], a[252:255], v[252:255], v[60:63]
    s_lshl_b32 s63, s76, 15
    s_add_u32 s63, s63, s73
    s_add_u32 s76, s76, 12
    s_add_u32 s27, s27, 1
    ds_write_b128 v39, v[56:59]
    s_nop 2
    ds_write_b128 v39, v[60:63] offset:1024
    s_waitcnt lgkmcnt(0)
    s_barrier
    s_cmp_lg_u32 s56, 0
    s_cbranch_scc1 L_EV
    ds_read_b128 v[224:227], v40 offset:2048
    ds_read_b128 v[228:231], v40 offset:3072
    ds_read_b128 v[232:235], v40 offset:4096
    ds_read_b128 v[236:239], v40 offset:5120
    ds_read_b128 v[240:243], v40 offset:6144
    ds_read_b128 v[244:247], v40 offset:7168
    s_waitcnt lgkmcnt(0)
    v_add_f32 v56, v56, v224
    v_add_f32 v232, v232, v240
    v_add_f32 v56, v56, v232
    v_add_f32 v57, v57, v225
    v_add_f32 v233, v233, v241
    v_add_f32 v57, v57, v233
    v_add_f32 v58, v58, v226
    v_add_f32 v234, v234, v242
    v_add_f32 v58, v58, v234
    v_add_f32 v59, v59, v227
    v_add_f32 v235, v235, v243
    v_add_f32 v59, v59, v235
    v_add_f32 v60, v60, v228
    v_add_f32 v236, v236, v244
    v_add_f32 v60, v60, v236
    v_add_f32 v61, v61, v229
    v_add_f32 v237, v237, v245
    v_add_f32 v61, v61, v237
    v_add_f32 v62, v62, v230
    v_add_f32 v238, v238, v246
    v_add_f32 v62, v62, v238
    v_add_f32 v63, v63, v231
    v_add_f32 v239, v239, v247
    v_add_f32 v63, v63, v239
    v_cvt_pk_bf16_f32 v56, v56, v57
    v_cvt_pk_bf16_f32 v57, v58, v59
    v_cvt_pk_bf16_f32 v58, v60, v61
    v_cvt_pk_bf16_f32 v59, v62, v63
    buffer_store_dwordx4 v[56:59], v34, s[52:55], s63 offen
    s_branch L_EV
L_HELPER:
    s_lshr_b32 s57, s62, 3
    v_lshlrev_b32 v1, 4, v0
    v_mov_b64 v[4:5], -1
    v_mov_b64 v[6:7], -1
    v_mov_b64 v[8:9], 0
    v_mov_b64 v[10:11], 0
    s_lshl_b32 s63, s57, 2
    s_add_u32 s66, s63, s56
    s_lshl_b32 s63, s66, 12
    s_add_u32 s63, s63, s97
    buffer_store_dwordx4 v[4:7], v1, s[36:39], s63 offen offset:0 sc1
    buffer_store_dwordx4 v[4:7], v1, s[36:39], s63 offen offset:1024 sc1
    buffer_store_dwordx4 v[4:7], v1, s[36:39], s63 offen offset:2048 sc1
    buffer_store_dwordx4 v[4:7], v1, s[36:39], s63 offen offset:3072 sc1
    s_lshl_b32 s63, s66, 10
    s_cmp_ge_u32 s57, 4
    s_cbranch_scc1 L_H1
    s_add_u32 s63, s63, s97
    s_add_u32 s63, s63, 1048576
    buffer_store_dwordx4 v[4:7], v1, s[36:39], s63 offen sc1
L_H1:
    s_cmp_lg_u32 s57, 4
    s_cbranch_scc1 L_H2
    s_lshl_b32 s63, s56, 10
    s_add_u32 s64, s63, 64032768
    s_add_u32 s63, s63, s97
    s_add_u32 s63, s63, 1114112
    buffer_store_dwordx4 v[8:11], v1, s[36:39], s63 offen sc1
    buffer_store_dwordx4 v[8:11], v1, s[36:39], s64 offen sc1
L_H2:
    s_waitcnt vmcnt(0)
    s_barrier
    s_cmp_lg_u32 s56, 0
    s_cbranch_scc1 L_na_31
    s_lshr_b32 s64, s62, 3
    s_lshl_b32 s64, 1, s64
    s_and_b32 s65, s62, 7
    s_lshl_b32 s65, s65, 5
    s_cmp_eq_u32 s96, 0
    s_cselect_b32 s64, s64, 0
    s_cselect_b32 s65, s65, 136
    v_mov_b32 v12, s64
    v_mov_b32 v13, 256
    v_lshlrev_b32 v14, 20, v0
    buffer_atomic_add_x2 v[12:13], v14, s[40:43], s65 offen sc1
L_na_31:
    s_mov_b32 s44, s26
    s_and_b32 s45, s27, 0xffff
    s_mov_b32 s46, 4194304
    s_mov_b32 s47, 0x20000
    s_lshl_b32 s63, s66, 10
    buffer_load_dwordx4 v[16:19], v1, s[44:47], s63 offen
    s_add_u32 s63, s63, 131072
    buffer_load_dwordx4 v[16:19], v1, s[44:47], s63 offen
    s_add_u32 s63, s63, 131072
    buffer_load_dwordx4 v[16:19], v1, s[44:47], s63 offen
    s_add_u32 s63, s63, 131072
    buffer_load_dwordx4 v[16:19], v1, s[44:47], s63 offen
    s_add_u32 s63, s63, 131072
    buffer_load_dwordx4 v[16:19], v1, s[44:47], s63 offen
    s_add_u32 s63, s63, 131072
    buffer_load_dwordx4 v[16:19], v1, s[44:47], s63 offen
    s_add_u32 s63, s63, 131072
    buffer_load_dwordx4 v[16:19], v1, s[44:47], s63 offen
    s_add_u32 s63, s63, 131072
    buffer_load_dwordx4 v[16:19], v1, s[44:47], s63 offen
    s_add_u32 s63, s63, 131072
    buffer_load_dwordx4 v[16:19], v1, s[44:47], s63 offen
    s_add_u32 s63, s63, 131072
    buffer_load_dwordx4 v[16:19], v1, s[44:47], s63 offen
    s_add_u32 s63, s63, 131072
    buffer_load_dwordx4 v[16:19], v1, s[44:47], s63 offen
    s_add_u32 s63, s63, 131072
    buffer_load_dwordx4 v[16:19], v1, s[44:47], s63 offen
    s_add_u32 s63, s63, 131072
    buffer_load_dwordx4 v[16:19], v1, s[44:47], s63 offen
    s_add_u32 s63, s63, 131072
    buffer_load_dwordx4 v[16:19], v1, s[44:47], s63 offen
    s_add_u32 s63, s63, 131072
    buffer_load_dwordx4 v[16:19], v1, s[44:47], s63 offen
    s_add_u32 s63, s63, 131072
    buffer_load_dwordx4 v[16:19], v1, s[44:47], s63 offen
    s_add_u32 s63, s63, 131072
    buffer_load_dwordx4 v[16:19], v1, s[44:47], s63 offen
    s_add_u32 s63, s63, 131072
    buffer_load_dwordx4 v[16:19], v1, s[44:47], s63 offen
    s_add_u32 s63, s63, 131072
    buffer_load_dwordx4 v[16:19], v1, s[44:47], s63 offen
    s_add_u32 s63, s63, 131072
    buffer_load_dwordx4 v[16:19], v1, s[44:47], s63 offen
    s_add_u32 s63, s63, 131072
    buffer_load_dwordx4 v[16:19], v1, s[44:47], s63 offen
    s_add_u32 s63, s63, 131072
    buffer_load_dwordx4 v[16:19], v1, s[44:47], s63 offen
    s_add_u32 s63, s63, 131072
    buffer_load_dwordx4 v[16:19], v1, s[44:47], s63 offen
    s_add_u32 s63, s63, 131072
    buffer_load_dwordx4 v[16:19], v1, s[44:47], s63 offen
    s_add_u32 s63, s63, 131072
    buffer_load_dwordx4 v[16:19], v1, s[44:47], s63 offen
    s_add_u32 s63, s63, 131072
    buffer_load_dwordx4 v[16:19], v1, s[44:47], s63 offen
    s_add_u32 s63, s63, 131072
    buffer_load_dwordx4 v[16:19], v1, s[44:47], s63 offen
    s_add_u32 s63, s63, 131072
    buffer_load_dwordx4 v[16:19], v1, s[44:47], s63 offen
    s_add_u32 s63, s63, 131072
    buffer_load_dwordx4 v[16:19], v1, s[44:47], s63 offen
    s_add_u32 s63, s63, 131072
    buffer_load_dwordx4 v[16:19], v1, s[44:47], s63 offen
    s_add_u32 s63, s63, 131072
    buffer_load_dwordx4 v[16:19], v1, s[44:47], s63 offen
    s_add_u32 s63, s63, 131072
    buffer_load_dwordx4 v[16:19], v1, s[44:47], s63 offen
    s_add_u32 s63, s63, 131072
    s_mov_b32 s44, s10
    s_and_b32 s45, s11, 0xffff
    s_mov_b32 s46, 1572864
    s_mov_b32 s47, 0x20000
    s_lshl_b32 s63, s66, 10
    buffer_load_dwordx4 v[16:19], v1, s[44:47], s63 offen
    s_add_u32 s63, s63, 131072
    buffer_load_dwordx4 v[16:19], v1, s[44:47], s63 offen
    s_add_u32 s63, s63, 131072
    buffer_load_dwordx4 v[16:19], v1, s[44:47], s63 offen
    s_add_u32 s63, s63, 131072
    buffer_load_dwordx4 v[16:19], v1, s[44:47], s63 offen
    s_add_u32 s63, s63, 131072
    buffer_load_dwordx4 v[16:19], v1, s[44:47], s63 offen
    s_add_u32 s63, s63, 131072
    buffer_load_dwordx4 v[16:19], v1, s[44:47], s63 offen
    s_add_u32 s63, s63, 131072
    buffer_load_dwordx4 v[16:19], v1, s[44:47], s63 offen
    s_add_u32 s63, s63, 131072
    buffer_load_dwordx4 v[16:19], v1, s[44:47], s63 offen
    s_add_u32 s63, s63, 131072
    buffer_load_dwordx4 v[16:19], v1, s[44:47], s63 offen
    s_add_u32 s63, s63, 131072
    buffer_load_dwordx4 v[16:19], v1, s[44:47], s63 offen
    s_add_u32 s63, s63, 131072
    buffer_load_dwordx4 v[16:19], v1, s[44:47], s63 offen
    s_add_u32 s63, s63, 131072
    buffer_load_dwordx4 v[16:19], v1, s[44:47], s63 offen
    s_add_u32 s63, s63, 131072
    s_mov_b32 s44, s8
    s_and_b32 s45, s9, 0xffff
    s_mov_b32 s46, 2097152
    s_mov_b32 s47, 0x20000
    s_lshl_b32 s63, s66, 10
    buffer_load_dwordx4 v[16:19], v1, s[44:47], s63 offen
    s_add_u32 s63, s63, 131072
    buffer_load_dwordx4 v[16:19], v1, s[44:47], s63 offen
    s_add_u32 s63, s63, 131072
    buffer_load_dwordx4 v[16:19], v1, s[44:47], s63 offen
    s_add_u32 s63, s63, 131072
    buffer_load_dwordx4 v[16:19], v1, s[44:47], s63 offen
    s_add_u32 s63, s63, 131072
    buffer_load_dwordx4 v[16:19], v1, s[44:47], s63 offen
    s_add_u32 s63, s63, 131072
    buffer_load_dwordx4 v[16:19], v1, s[44:47], s63 offen
    s_add_u32 s63, s63, 131072
    buffer_load_dwordx4 v[16:19], v1, s[44:47], s63 offen
    s_add_u32 s63, s63, 131072
    buffer_load_dwordx4 v[16:19], v1, s[44:47], s63 offen
    s_add_u32 s63, s63, 131072
    buffer_load_dwordx4 v[16:19], v1, s[44:47], s63 offen
    s_add_u32 s63, s63, 131072
    buffer_load_dwordx4 v[16:19], v1, s[44:47], s63 offen
    s_add_u32 s63, s63, 131072
    buffer_load_dwordx4 v[16:19], v1, s[44:47], s63 offen
    s_add_u32 s63, s63, 131072
    buffer_load_dwordx4 v[16:19], v1, s[44:47], s63 offen
    s_add_u32 s63, s63, 131072
    buffer_load_dwordx4 v[16:19], v1, s[44:47], s63 offen
    s_add_u32 s63, s63, 131072
    buffer_load_dwordx4 v[16:19], v1, s[44:47], s63 offen
    s_add_u32 s63, s63, 131072
    buffer_load_dwordx4 v[16:19], v1, s[44:47], s63 offen
    s_add_u32 s63, s63, 131072
    buffer_load_dwordx4 v[16:19], v1, s[44:47], s63 offen
    s_add_u32 s63, s63, 131072
    s_mov_b32 s44, s14
    s_and_b32 s45, s15, 0xffff
    s_mov_b32 s46, 524288
    s_mov_b32 s47, 0x20000
    s_lshl_b32 s63, s66, 10
    buffer_load_dwordx4 v[16:19], v1, s[44:47], s63 offen
    s_add_u32 s63, s63, 131072
    buffer_load_dwordx4 v[16:19], v1, s[44:47], s63 offen
    s_add_u32 s63, s63, 131072
    buffer_load_dwordx4 v[16:19], v1, s[44:47], s63 offen
    s_add_u32 s63, s63, 131072
    buffer_load_dwordx4 v[16:19], v1, s[44:47], s63 offen
    s_add_u32 s63, s63, 131072
    s_waitcnt vmcnt(0)
    v_and_b32 v22, 7, v0
    v_lshlrev_b32 v22, 5, v22
    s_cmp_eq_u32 s96, 0
    s_cselect_b32 s63, 0, 8
    v_add_u32 v22, s63, v22
    buffer_load_dwordx2 v[20:21], v22, s[40:43], 0 offen sc1
    s_waitcnt vmcnt(0)
L_arr_33:
    s_mov_b32 s64, 0
    v_readlane_b32 s63, v21, 0
    s_nop 0
    s_lshr_b32 s63, s63, 8
    s_add_u32 s64, s64, s63
    v_readlane_b32 s63, v21, 1
    s_nop 0
    s_lshr_b32 s63, s63, 8
    s_add_u32 s64, s64, s63
    v_readlane_b32 s63, v21, 2
    s_nop 0
    s_lshr_b32 s63, s63, 8
    s_add_u32 s64, s64, s63
    v_readlane_b32 s63, v21, 3
    s_nop 0
    s_lshr_b32 s63, s63, 8
    s_add_u32 s64, s64, s63
    v_readlane_b32 s63, v21, 4
    s_nop 0
    s_lshr_b32 s63, s63, 8
    s_add_u32 s64, s64, s63
    v_readlane_b32 s63, v21, 5
    s_nop 0
    s_lshr_b32 s63, s63, 8
    s_add_u32 s64, s64, s63
    v_readlane_b32 s63, v21, 6
    s_nop 0
    s_lshr_b32 s63, s63, 8
    s_add_u32 s64, s64, s63
    v_readlane_b32 s63, v21, 7
    s_nop 0
    s_lshr_b32 s63, s63, 8
    s_add_u32 s64, s64, s63
    s_cmp_ge_u32 s64, 256
    s_cbranch_scc1 L_arrd_34
    buffer_load_dwordx2 v[20:21], v22, s[40:43], 0 offen sc1
    s_sub_u32 s61, s61, 1
    s_cbranch_scc1 L_END
    s_waitcnt vmcnt(0)
    s_branch L_arr_33
L_arrd_34:
    s_cmp_lg_u32 s96, 0
    s_cbranch_scc1 L_arrk_35
    v_cmp_ne_u32 vcc, -1, v20
    s_cbranch_vccnz L_RESTART
    v_cmp_ne_u32 vcc, 8192, v21
    s_cbranch_vccnz L_RESTART
L_arrk_35:
    s_endpgm
    s_endpgm
L_RESTART:
    s_waitcnt vmcnt(0) lgkmcnt(0)
    s_barrier
    v_mbcnt_lo_u32_b32 v0, -1, 0
    v_mbcnt_hi_u32_b32 v0, -1, v0
    v_mov_b32 v2, 1
    v_lshlrev_b32 v3, 20, v0
    v_mov_b32 v4, 16
    s_cmp_lg_u32 s56, 0
    s_cbranch_scc1 L_RS_WAIT
    buffer_atomic_add v2, v3, s[40:43], 0 offen offset:16 sc1
L_RS_WAIT:
    buffer_load_dword v5, v4, s[40:43], 0 offen sc1
    s_sub_u32 s61, s61, 1
    s_cbranch_scc1 L_END
    s_sleep 8
    s_waitcnt vmcnt(0)
    v_cmp_gt_u32 vcc, 256, v5
    s_cbranch_vccnz L_RS_WAIT
    s_mov_b32 s96, 1
    s_mov_b32 s62, s2
    s_branch L_START
L_END:
    s_endpgm
.section .rodata,"a"
.p2align 6
.amdhsa_kernel concat_heads__linear_kernel_hedgehog__memory_aug_recurrent_mem_tr__prompt_kernel
  .amdhsa_next_free_vgpr 512
  .amdhsa_next_free_sgpr 102
  .amdhsa_accum_offset 256
  .amdhsa_group_segment_fixed_size 0
  .amdhsa_kernarg_size 112
  .amdhsa_user_sgpr_count 2
  .amdhsa_user_sgpr_kernarg_segment_ptr 1
  .amdhsa_system_sgpr_workgroup_id_x 1
  .amdhsa_float_denorm_mode_32 3
.end_amdhsa_kernel
```
